```python
import torch

def _softmax(x, axis=-1):
    return torch.softmax(x, dim=axis)
def _gelu(x):
    return torch.nn.functional.gelu(x, approximate="tanh")
def _silu(x):
    return torch.nn.functional.silu(x)
def _sigmoid(x):
    return torch.sigmoid(x)
def _layernorm(x, axis=-1, eps=1e-5):
    m = x.mean(dim=axis, keepdim=True)
    v = x.var(dim=axis, keepdim=True, unbiased=False)
    return (x - m) / torch.sqrt(v + eps)
def _scatter_add(tgt, idx, src, axis=0):
    return tgt.clone().index_add_(axis, idx, src)
def _segment_sum(src, seg, n):
    out = torch.zeros((n,) + src.shape[1:], dtype=src.dtype)
    return out.index_add_(0, seg, src)
def _pad(x, pw):
    flat = tuple(v for pair in reversed(pw) for v in pair)
    return torch.nn.functional.pad(x, flat)

kernel_name = 'gated_mix__ssm_conv_s4__glu_gated_glu__prompt'

def setup_inputs():

    _w = (lambda a: (lambda t: t.to(torch.bfloat16) if t.is_floating_point() else t)(torch.as_tensor(a)))
    def _A_setup():
        B, L, D, N = 1, 2048, 448, 256
        A_re = -(lambda _x: torch.exp(torch.as_tensor(_x)))((lambda *s: torch.randn(*s, dtype=torch.bfloat16) * 6.4)(D, N))
        A_im = torch.pi * (lambda *s: torch.randn(*s, dtype=torch.bfloat16) * 0.1)(D, N)
        B_re = (lambda *s: torch.randn(*s, dtype=torch.bfloat16) * 0.2)(D, N)
        B_im = (lambda *s: torch.randn(*s, dtype=torch.bfloat16) * 0.2)(D, N)
        C_re = (lambda *s: torch.randn(*s, dtype=torch.bfloat16) * 0.2)(D, N)
        C_im = (lambda *s: torch.randn(*s, dtype=torch.bfloat16) * 0.2)(D, N)
        log_dt = (lambda *s: torch.randn(*s, dtype=torch.bfloat16) * 0.1)(D) * 0.5 - 4.0
        Dskip = (lambda *s: torch.randn(*s, dtype=torch.bfloat16) * 0.1)(D)
        return {
            "u": _w((lambda *s: torch.randn(*s, dtype=torch.bfloat16) * 0.05)(B, L, D)),
            "A_re": _w(A_re),
            "A_im": _w(A_im),
            "B_re": _w(B_re),
            "B_im": _w(B_im),
            "C_re": _w(C_re),
            "C_im": _w(C_im),
            "log_dt": _w(log_dt),
            "Dskip": _w(Dskip),
        }
    _A_in = _A_setup()

    def _B_setup():
        B, S, D, F = 1, 2048, 448, 1792
        return {
            "x": _w((lambda *s: torch.randn(*s, dtype=torch.bfloat16) * 0.05)(B, S, D)),
            "w_gate": _w((lambda *s: torch.randn(*s, dtype=torch.bfloat16) * 0.4)(D, F)),
            "w_up": _w((lambda *s: torch.randn(*s, dtype=torch.bfloat16) * 0.05)(D, F)),
            "w_down": _w((lambda *s: torch.randn(*s, dtype=torch.bfloat16) * 0.05)(F, D)),
        }
    _B_in = _B_setup()

    return {
        "A_u": _A_in["u"],
        "A_A_re": _A_in["A_re"],
        "A_A_im": _A_in["A_im"],
        "A_B_re": _A_in["B_re"],
        "A_B_im": _A_in["B_im"],
        "A_C_re": _A_in["C_re"],
        "A_C_im": _A_in["C_im"],
        "A_log_dt": _A_in["log_dt"],
        "A_Dskip": _A_in["Dskip"],
        "B_x": _B_in["x"],
        "B_w_gate": _B_in["w_gate"],
        "B_w_up": _B_in["w_up"],
        "B_w_down": _B_in["w_down"],
        "gate_w": _w((lambda *s: torch.randn(*s, dtype=torch.bfloat16) * 0.05)(448) * 16.0),
    }

def reference(A_u, A_A_re, A_A_im, A_B_re, A_B_im, A_C_re, A_C_im, A_log_dt, A_Dskip, B_x, B_w_gate, B_w_up, B_w_down, gate_w):
    def _A_ref(u, A_re, A_im, B_re, B_im, C_re, C_im, log_dt, Dskip):
        Bsz, L, D = u.shape
        dt = torch.exp(log_dt)[:, None]
        A = A_re + 1j * A_im
        Bc = B_re + 1j * B_im
        Cc = C_re + 1j * C_im
        logdA = dt * A
        dB = dt * Bc
        l = (lambda x, dt: x.to(dt))(torch.arange(L), A_re.dtype)
        P = torch.exp(logdA[:, :, None] * l[None, None, :])
        K = torch.einsum("dn,dnl,dn->dl", Cc, P, dB).real
        L2 = 2 * L
        Kp = _pad(K, ((0, 0), (0, L)))
        up = (lambda x, *d: x.permute(*d))(u, 0, 2, 1)
        up = _pad(up, ((0, 0), (0, 0), (0, L)))
        Kf = (lambda x, axes=(-2,-1): torch.fft.rfft2(x.float(), dim=axes))(Kp[:, None, :], axes=(-2, -1))
        Uf = (lambda x, axes=(-2,-1): torch.fft.rfft2(x.float(), dim=axes))(up[:, :, None, :], axes=(-2, -1))
        Yf = Uf * Kf[None, :, :, :]
        y = (lambda x, s, axes=(-2,-1): torch.fft.irfft2(x, s=s, dim=axes).to(torch.bfloat16))(Yf, (1, L2), axes=(-2, -1))[:, :, 0, :L]
        y = (lambda x, *d: x.permute(*d))(y, 0, 2, 1) + u * Dskip[None, None, :]
        return y

    def _B_ref(x, w_gate, w_up, w_down):
        g = torch.einsum("bsd,df->bsf", x, w_gate)
        u = torch.einsum("bsd,df->bsf", x, w_up)
        h = _sigmoid(g) * u
        return torch.einsum("bsf,fd->bsd", h, w_down)

    x = A_u
    g = _sigmoid((x * gate_w).sum(-1, keepdims=True))
    a = _A_ref(x, A_A_re, A_A_im, A_B_re, A_B_im, A_C_re, A_C_im, A_log_dt, A_Dskip)
    b = _B_ref(x, B_w_gate, B_w_up, B_w_down)
    return g * a + (1 - g) * b
```

```asm
; @launch grid=(256,1,1) block=(512,1,1) lds=163840
.amdgcn_target "amdgcn-amd-amdhsa--gfx950"
.text
.globl gated_mix__ssm_conv_s4__glu_gated_glu__prompt_kernel
.p2align 8
.type gated_mix__ssm_conv_s4__glu_gated_glu__prompt_kernel,@function
gated_mix__ssm_conv_s4__glu_gated_glu__prompt_kernel:
    v_lshrrev_b32 v1, 6, v0
    v_and_b32 v2, 63, v0
    v_readfirstlane_b32 s28, v1
    s_cmp_lt_u32 s2, 224
    s_cbranch_scc1 K_AB
    s_getpc_b64 s[44:45]
K_pc:
    s_sub_u32 s44, s44, K_pc-gated_mix__ssm_conv_s4__glu_gated_glu__prompt_kernel
    s_subb_u32 s45, s45, 0
    s_cmp_eq_u32 s28, 0
    s_cselect_b32 s46, K_end-gated_mix__ssm_conv_s4__glu_gated_glu__prompt_kernel, 0
    s_mov_b32 s47, 0x20000
    s_and_b32 s3, s2, 24
    s_lshl_b32 s3, s3, 4
    v_lshlrev_b32 v8, 9, v2
    buffer_load_dword v21, v8, s[44:47], s3 offen
    s_branch K_notAB
K_AB:
    s_load_dwordx2 s[4:5], s[0:1], 0
    s_load_dwordx4 s[8:11], s[0:1], 80
    s_load_dwordx4 s[56:59], s[0:1], 112
    s_load_dwordx2 s[6:7], s[0:1], 128
    s_load_dwordx2 s[54:55], s[0:1], 96
    s_lshr_b32 s29, s28, 2
    s_and_b32 s28, s28, 3
    s_cmp_eq_u32 s29, 0
    s_cbranch_scc1 K_c1
    s_load_dwordx4 s[72:75], s[0:1], 8
    s_load_dwordx4 s[84:87], s[0:1], 56
    s_load_dwordx8 s[88:95], s[0:1], 24
    s_lshr_b32 s36, s28, 1
    s_and_b32 s37, s28, 1
    s_lshl_b32 s3, s2, 1
    s_add_u32 s3, s3, s36
    s_lshl_b32 s34, s3, 9
    s_lshl_b32 s35, s37, 8
    s_add_u32 s34, s34, s35
    v_lshlrev_b32 v40, 2, v2
    v_add_u32 v40, s34, v40
    s_lshl_b32 s34, s3, 1
    v_mov_b32 v41, s34
K_c1:
    v_and_b32 v1, 3, v1
    s_and_b32 s30, s2, 7
    s_lshr_b32 s31, s2, 3
    s_mul_i32 s32, s31, 9363
    s_lshr_b32 s32, s32, 16
    s_mul_i32 s34, s32, 7
    s_sub_u32 s40, s31, s34
    s_mov_b32 s61, s32
    s_lshr_b32 s34, s30, 1
    s_lshl_b32 s34, s34, 2
    s_add_u32 s32, s32, s34
    s_and_b32 s41, s30, 1
    s_mul_i32 s34, s41, 7
    s_add_u32 s33, s40, s34
    v_lshrrev_b32 v3, 3, v2
    v_lshl_add_u32 v3, v1, 5, v3
    v_mul_u32_u24 v3, 896, v3
    v_lshrrev_b32 v4, 4, v2
    v_xor_b32 v5, v4, v2
    v_and_b32 v5, 7, v5
    v_lshl_add_u32 v8, v5, 4, v3
    v_xor_b32 v5, 4, v5
    v_lshl_add_u32 v9, v5, 4, v3
    v_add_u32 v9, 6144, v9
    v_add_u32 v10, 12288, v8
    v_add_u32 v11, 12288, v9
    v_lshl_add_u32 v3, v1, 2, v4
    v_mul_u32_u24 v3, 3584, v3
    v_lshlrev_b32 v5, 2, v4
    v_xor_b32 v5, v5, v2
    v_and_b32 v5, 15, v5
    v_lshl_add_u32 v12, v5, 4, v3
    s_lshl_b32 s38, s28, 12
    s_add_u32 s38, s38, 100864
    s_lshl_b32 s39, s28, 11
    s_mul_i32 s34, s32, 114688
    s_lshl_b32 s35, s33, 8
    s_mov_b32 s14, 114688
    s_mov_b32 s15, 0x20000
    s_sub_u32 s18, 1605632, s35
    s_mov_b32 s19, 0x20000
    s_add_u32 s22, s18, 1024
    s_mov_b32 s23, 0x20000
    s_waitcnt lgkmcnt(0)
    s_add_u32 s12, s4, s34
    s_addc_u32 s13, s5, 0
    s_add_u32 s16, s8, s35
    s_addc_u32 s17, s9, 0
    s_add_u32 s20, s10, s35
    s_addc_u32 s21, s11, 0
    s_sub_u32 s20, s20, 1024
    s_subb_u32 s21, s21, 0
    s_cmp_lg_u32 s29, 0
    s_cbranch_scc1 K_B
    s_mov_b32 s36, 0
    s_mov_b32 s37, 0
    v_mov_b32 v23, 0
    s_or_b32 s34, s2, s28
    s_cmp_lg_u32 s34, 0
    s_cbranch_scc1 A_notag
    s_memrealtime s[60:61]
    s_waitcnt lgkmcnt(0)
    s_or_b32 s60, s60, 1
    v_mov_b32 v22, s60
    s_mov_b64 exec, 1
    global_store_dword v23, v22, s[58:59] sc1
    s_mov_b64 exec, -1
A_notag:
    s_mov_b32 m0, s39
    s_add_u32 s39, s39, 8192
    buffer_load_dwordx4 v12, s[16:19], s37 offen offset:0 lds
    s_and_b32 s39, s39, 0xffff
    buffer_load_dwordx4 v12, s[20:23], s37 offen offset:1024 lds
    s_add_u32 s37, s37, 57344
    s_mov_b32 m0, s38
    s_add_u32 s38, s38, 16384
    buffer_load_dwordx4 v8, s[12:15], s36 offen offset:0 lds
    buffer_load_dwordx4 v9, s[12:15], s36 offen offset:1024 lds
    buffer_load_dwordx4 v10, s[12:15], s36 offen offset:2048 lds
    buffer_load_dwordx4 v11, s[12:15], s36 offen offset:3072 lds
    s_add_u32 s36, s36, 128
    v_and_b32 v3, 31, v2
    v_lshrrev_b32 v4, 5, v2
    v_and_b32 v5, 1, v1
    v_lshl_add_u32 v5, v5, 6, v3
    v_lshlrev_b32 v5, 7, v5
    v_add_u32 v5, 100864, v5
    v_bfe_u32 v6, v3, 1, 3
    v_xor_b32 v6, v6, v4
    v_xor_b32 v7, 0, v6
    v_lshl_add_u32 v14, v7, 4, v5
    v_xor_b32 v7, 2, v6
    v_lshl_add_u32 v15, v7, 4, v5
    v_xor_b32 v7, 4, v6
    v_lshl_add_u32 v16, v7, 4, v5
    v_xor_b32 v7, 6, v6
    v_lshl_add_u32 v17, v7, 4, v5
    v_bfe_u32 v3, v2, 2, 2
    v_lshlrev_b32 v5, 12, v4
    v_lshl_add_u32 v5, v3, 8, v5
    v_bfe_u32 v6, v2, 4, 1
    v_lshl_add_u32 v5, v6, 5, v5
    v_and_b32 v6, 3, v2
    v_lshl_add_u32 v5, v6, 3, v5
    v_and_b32 v6, 2, v1
    v_xor_b32 v6, v6, v3
    v_lshl_add_u32 v18, v6, 6, v5
    v_xor_b32 v6, 1, v6
    v_lshl_add_u32 v19, v6, 6, v5
    v_lshlrev_b32 v20, 4, v2
    v_mov_b32 v24, 0
    v_mov_b32 v25, 0
    v_mov_b32 v26, 0
    v_mov_b32 v27, 0
    s_mov_b32 m0, s39
    s_add_u32 s39, s39, 8192
    buffer_load_dwordx4 v12, s[16:19], s37 offen offset:0 lds
    s_and_b32 s39, s39, 0xffff
    buffer_load_dwordx4 v12, s[20:23], s37 offen offset:1024 lds
    s_add_u32 s37, s37, 57344
    s_lshl_b32 s39, s28, 11
    s_mov_b32 s37, 458752
    v_mfma_f32_32x32x16_bf16 v[72:87], v[24:27], v[24:27], 0
    v_mfma_f32_32x32x16_bf16 v[88:103], v[24:27], v[24:27], 0
    v_mfma_f32_32x32x16_bf16 v[104:119], v[24:27], v[24:27], 0
    v_mfma_f32_32x32x16_bf16 v[120:135], v[24:27], v[24:27], 0
    v_mfma_f32_32x32x16_bf16 v[136:151], v[24:27], v[24:27], 0
    v_mfma_f32_32x32x16_bf16 v[152:167], v[24:27], v[24:27], 0
    v_mfma_f32_32x32x16_bf16 v[168:183], v[24:27], v[24:27], 0
    v_mfma_f32_32x32x16_bf16 v[184:199], v[24:27], v[24:27], 0
    s_mov_b32 s24, s6
    s_mov_b32 s25, s7
    s_mov_b32 s26, 7340032
    s_mov_b32 s27, 0x20000
    s_mov_b32 s44, s54
    s_mov_b32 s45, s55
    s_mov_b32 s46, 1605632
    s_mov_b32 s47, 0x20000
    s_add_u32 s48, s6, 12615680
    s_addc_u32 s49, s7, 0
    s_mov_b32 s50, 348160
    s_mov_b32 s51, 0x20000
    s_movk_i32 s43, 16384
    s_mov_b32 s42, 0
    s_mov_b32 s34, 0
    s_lshr_b32 s36, s28, 1
    s_and_b32 s37, s28, 1
    v_lshrrev_b32 v3, 3, v2
    v_mul_u32_u24 v3, 896, v3
    v_bfe_u32 v4, v2, 4, 1
    v_lshlrev_b32 v4, 2, v4
    v_xor_b32 v4, v4, v2
    v_and_b32 v4, 7, v4
    v_lshl_add_u32 v3, v4, 4, v3
    s_mul_i32 s34, s28, 401408
    s_lshl_b32 s52, s40, 7
    s_add_u32 s34, s34, s52
    v_add_u32 v8, s34, v3
    v_add_u32 v9, 6144, v8
    v_lshrrev_b32 v3, 5, v2
    v_bfe_u32 v4, v2, 2, 2
    v_lshl_add_u32 v3, v3, 2, v4
    v_lshlrev_b32 v3, 7, v3
    v_bfe_u32 v4, v2, 3, 1
    v_xor_b32 v4, s36, v4
    v_lshl_add_u32 v3, v4, 6, v3
    v_bfe_u32 v4, v2, 4, 1
    v_lshl_add_u32 v3, v4, 5, v3
    v_and_b32 v4, 3, v2
    v_lshl_add_u32 v21, v4, 3, v3
    v_xor_b32 v22, 64, v21
    s_mul_i32 s29, s28, 16384
    s_lshl_b32 s60, s36, 2
    s_add_u32 s60, s60, s37
    s_lshl_b32 s60, s60, 13
    s_add_u32 s60, s60, 100864
    v_add_u32 v6, s60, v21
    v_add_u32 v7, s60, v22
    v_add_u32 v21, s29, v21
    v_add_u32 v22, s29, v22
    s_mul_i32 s38, s28, 28672
    s_lshl_b32 s39, s32, 1
    s_add_u32 s39, s39, s41
    s_xor_b32 s34, s37, 0
    s_lshl_b32 s61, s39, 1
    s_add_u32 s34, s34, s61
    s_mul_i32 s34, s34, 114688
    s_add_u32 s34, s34, s38
    v_add_u32 v10, s34, v20
    s_xor_b32 s34, s37, 1
    s_lshl_b32 s61, s39, 1
    s_add_u32 s34, s34, s61
    s_mul_i32 s34, s34, 114688
    s_add_u32 s34, s34, s38
    v_add_u32 v11, s34, v20
    s_lshl_b32 s34, s28, 2
    s_add_u32 s34, s34, 159232
    v_mov_b32 v3, s34
    v_mov_b32 v4, 1
    v_mov_b32 v5, 159232
    s_lshl_b32 s30, s37, 1
    s_lshl_b32 s31, s32, 2
    s_add_u32 s30, s30, s31
    s_mul_i32 s30, s30, 112
    s_lshl_b32 s31, s33, 3
    s_add_u32 s30, s30, s31
    s_lshl_b32 s31, s36, 2
    s_add_u32 s30, s30, s31
    s_lshl_b32 s30, s30, 10
    s_add_u32 s31, s30, 114688
    s_mov_b32 s52, 0xbfb8aa3b
    s_mov_b32 s53, 0xbfb8aa3b
    s_mov_b32 s54, 1.0
    s_mov_b32 s55, 1.0
    s_mov_b32 s34, 0
    s_movk_i32 s35, 16384
    s_mov_b32 s95, 0
    s_lshl_b32 s88, s95, 12
    s_add_u32 s89, s88, 4096
    s_cmp_eq_u32 s89, 28672
    s_cselect_b32 s89, 0, s89
    s_add_u32 s90, s89, 4096
    s_cmp_eq_u32 s90, 28672
    s_cselect_b32 s90, 0, s90
    s_add_u32 s91, s90, 4096
    s_cmp_eq_u32 s91, 28672
    s_cselect_b32 s91, 0, s91
    s_add_u32 s92, s91, 4096
    s_cmp_eq_u32 s92, 28672
    s_cselect_b32 s92, 0, s92
    s_add_u32 s93, s92, 4096
    s_cmp_eq_u32 s93, 28672
    s_cselect_b32 s93, 0, s93
    s_add_u32 s94, s93, 4096
    s_cmp_eq_u32 s94, 28672
    s_cselect_b32 s94, 0, s94
    s_mov_b32 s10, 0
    s_waitcnt vmcnt(2)
    s_barrier
    ds_read_b128 v[24:27], v14
    ds_read_b64_tr_b16 v[32:33], v18 offset:0
    ds_read_b64_tr_b16 v[34:35], v18 offset:2048
    ds_read_b64_tr_b16 v[36:37], v18 offset:1024
    ds_read_b64_tr_b16 v[38:39], v18 offset:3072
    ds_read_b128 v[28:31], v14 offset:4096
    ds_read_b64_tr_b16 v[40:41], v19 offset:0
    ds_read_b64_tr_b16 v[42:43], v19 offset:2048
    ds_read_b64_tr_b16 v[44:45], v19 offset:1024
    ds_read_b64_tr_b16 v[46:47], v19 offset:3072
    v_add_u32 v14, s43, v14
A_loop:
    s_waitcnt vmcnt(0) lgkmcnt(0)
    s_barrier
    v_mfma_f32_32x32x16_bf16 v[72:87], v[32:35], v[24:27], v[72:87]
    ds_read_b128 v[48:51], v15
    ds_read_b64_tr_b16 v[56:57], v18 offset:8192
    v_mfma_f32_32x32x16_bf16 v[88:103], v[36:39], v[24:27], v[88:103]
    ds_read_b64_tr_b16 v[58:59], v18 offset:10240
    ds_read_b64_tr_b16 v[60:61], v18 offset:9216
    ds_read_b64_tr_b16 v[62:63], v18 offset:11264
    v_mfma_f32_32x32x16_bf16 v[136:151], v[32:35], v[28:31], v[136:151]
    ds_read_b128 v[52:55], v15 offset:4096
    ds_read_b64_tr_b16 v[64:65], v19 offset:8192
    v_mfma_f32_32x32x16_bf16 v[152:167], v[36:39], v[28:31], v[152:167]
    ds_read_b64_tr_b16 v[66:67], v19 offset:10240
    ds_read_b64_tr_b16 v[68:69], v19 offset:9216
    ds_read_b64_tr_b16 v[70:71], v19 offset:11264
    v_mfma_f32_32x32x16_bf16 v[104:119], v[40:43], v[24:27], v[104:119]
    v_mfma_f32_32x32x16_bf16 v[120:135], v[44:47], v[24:27], v[120:135]
    v_add_u32 v15, s43, v15
    v_mfma_f32_32x32x16_bf16 v[168:183], v[40:43], v[28:31], v[168:183]
    v_mfma_f32_32x32x16_bf16 v[184:199], v[44:47], v[28:31], v[184:199]
    s_waitcnt lgkmcnt(0)
    s_barrier
    v_mfma_f32_32x32x16_bf16 v[72:87], v[56:59], v[48:51], v[72:87]
    ds_read_b128 v[24:27], v16
    ds_read_b64_tr_b16 v[32:33], v18 offset:16384
    v_mfma_f32_32x32x16_bf16 v[88:103], v[60:63], v[48:51], v[88:103]
    ds_read_b64_tr_b16 v[34:35], v18 offset:18432
    ds_read_b64_tr_b16 v[36:37], v18 offset:17408
    ds_read_b64_tr_b16 v[38:39], v18 offset:19456
    v_mfma_f32_32x32x16_bf16 v[136:151], v[56:59], v[52:55], v[136:151]
    ds_read_b128 v[28:31], v16 offset:4096
    ds_read_b64_tr_b16 v[40:41], v19 offset:16384
    v_mfma_f32_32x32x16_bf16 v[152:167], v[60:63], v[52:55], v[152:167]
    ds_read_b64_tr_b16 v[42:43], v19 offset:18432
    ds_read_b64_tr_b16 v[44:45], v19 offset:17408
    ds_read_b64_tr_b16 v[46:47], v19 offset:19456
    v_mfma_f32_32x32x16_bf16 v[104:119], v[64:67], v[48:51], v[104:119]
    v_mfma_f32_32x32x16_bf16 v[120:135], v[68:71], v[48:51], v[120:135]
    v_add_u32 v16, s43, v16
    v_mfma_f32_32x32x16_bf16 v[168:183], v[64:67], v[52:55], v[168:183]
    v_mfma_f32_32x32x16_bf16 v[184:199], v[68:71], v[52:55], v[184:199]
    s_waitcnt lgkmcnt(0)
    s_barrier
    v_mfma_f32_32x32x16_bf16 v[72:87], v[32:35], v[24:27], v[72:87]
    ds_read_b128 v[48:51], v17
    ds_read_b64_tr_b16 v[56:57], v18 offset:24576
    v_mfma_f32_32x32x16_bf16 v[88:103], v[36:39], v[24:27], v[88:103]
    ds_read_b64_tr_b16 v[58:59], v18 offset:26624
    ds_read_b64_tr_b16 v[60:61], v18 offset:25600
    ds_read_b64_tr_b16 v[62:63], v18 offset:27648
    v_mfma_f32_32x32x16_bf16 v[136:151], v[32:35], v[28:31], v[136:151]
    ds_read_b128 v[52:55], v17 offset:4096
    ds_read_b64_tr_b16 v[64:65], v19 offset:24576
    v_mfma_f32_32x32x16_bf16 v[152:167], v[36:39], v[28:31], v[152:167]
    ds_read_b64_tr_b16 v[66:67], v19 offset:26624
    ds_read_b64_tr_b16 v[68:69], v19 offset:25600
    ds_read_b64_tr_b16 v[70:71], v19 offset:27648
    v_mfma_f32_32x32x16_bf16 v[104:119], v[40:43], v[24:27], v[104:119]
    v_mfma_f32_32x32x16_bf16 v[120:135], v[44:47], v[24:27], v[120:135]
    v_add_u32 v17, s43, v17
    v_xor_b32 v18, 0x8000, v18
    v_xor_b32 v19, 0x8000, v19
    v_mfma_f32_32x32x16_bf16 v[168:183], v[40:43], v[28:31], v[168:183]
    v_mfma_f32_32x32x16_bf16 v[184:199], v[44:47], v[28:31], v[184:199]
    s_add_u32 s42, s42, 1
    s_cmp_eq_u32 s42, 3
    s_cselect_b32 s42, 0, s42
    s_cmp_eq_u32 s42, 2
    s_cselect_b32 s43, -32768, s35
    s_waitcnt lgkmcnt(0)
    s_barrier
    v_mfma_f32_32x32x16_bf16 v[72:87], v[56:59], v[48:51], v[72:87]
    ds_read_b128 v[24:27], v14
    ds_read_b64_tr_b16 v[32:33], v18 offset:0
    v_mfma_f32_32x32x16_bf16 v[88:103], v[60:63], v[48:51], v[88:103]
    ds_read_b64_tr_b16 v[34:35], v18 offset:2048
    ds_read_b64_tr_b16 v[36:37], v18 offset:1024
    ds_read_b64_tr_b16 v[38:39], v18 offset:3072
    v_mfma_f32_32x32x16_bf16 v[136:151], v[56:59], v[52:55], v[136:151]
    ds_read_b128 v[28:31], v14 offset:4096
    ds_read_b64_tr_b16 v[40:41], v19 offset:0
    v_mfma_f32_32x32x16_bf16 v[152:167], v[60:63], v[52:55], v[152:167]
    ds_read_b64_tr_b16 v[42:43], v19 offset:2048
    ds_read_b64_tr_b16 v[44:45], v19 offset:1024
    ds_read_b64_tr_b16 v[46:47], v19 offset:3072
    v_mfma_f32_32x32x16_bf16 v[104:119], v[64:67], v[48:51], v[104:119]
    v_mfma_f32_32x32x16_bf16 v[120:135], v[68:71], v[48:51], v[120:135]
    v_add_u32 v14, s43, v14
    v_mfma_f32_32x32x16_bf16 v[168:183], v[64:67], v[52:55], v[168:183]
    v_mfma_f32_32x32x16_bf16 v[184:199], v[68:71], v[52:55], v[184:199]
    s_add_u32 s34, s34, 1
    s_cmp_lg_u32 s34, 5
    s_cbranch_scc1 A_loop
    v_subrev_u32 v15, 0x8000, v15
    v_subrev_u32 v16, 0x8000, v16
    v_subrev_u32 v17, 0x8000, v17
    v_xor_b32 v18, 0x8000, v18
    v_xor_b32 v19, 0x8000, v19
    s_waitcnt lgkmcnt(0)
    s_barrier
    v_mfma_f32_32x32x16_bf16 v[72:87], v[32:35], v[24:27], v[72:87]
    ds_read_b128 v[48:51], v15 offset:32768
    ds_read_b64_tr_b16 v[56:57], v18 offset:40960
    ds_read_b64_tr_b16 v[58:59], v18 offset:43008
    v_mfma_f32_32x32x16_bf16 v[88:103], v[36:39], v[24:27], v[88:103]
    ds_read_b128 v[52:55], v15 offset:36864
    ds_read_b64_tr_b16 v[60:61], v18 offset:41984
    ds_read_b64_tr_b16 v[62:63], v18 offset:44032
    v_mfma_f32_32x32x16_bf16 v[136:151], v[32:35], v[28:31], v[136:151]
    ds_read_b128 v[64:67], v16 offset:32768
    ds_read_b64_tr_b16 v[240:241], v18 offset:49152
    ds_read_b64_tr_b16 v[242:243], v18 offset:51200
    v_mfma_f32_32x32x16_bf16 v[152:167], v[36:39], v[28:31], v[152:167]
    ds_read_b128 v[68:71], v16 offset:36864
    ds_read_b64_tr_b16 v[244:245], v18 offset:50176
    ds_read_b64_tr_b16 v[246:247], v18 offset:52224
    v_mfma_f32_32x32x16_bf16 v[104:119], v[40:43], v[24:27], v[104:119]
    v_mfma_f32_32x32x16_bf16 v[120:135], v[44:47], v[24:27], v[120:135]
    v_mfma_f32_32x32x16_bf16 v[168:183], v[40:43], v[28:31], v[168:183]
    v_mfma_f32_32x32x16_bf16 v[184:199], v[44:47], v[28:31], v[184:199]
    s_waitcnt lgkmcnt(0)
    s_barrier
    v_mfma_f32_32x32x16_bf16 v[72:87], v[56:59], v[48:51], v[72:87]
    ds_read_b128 v[24:27], v17 offset:32768
    ds_read_b64_tr_b16 v[32:33], v18 offset:57344
    ds_read_b64_tr_b16 v[34:35], v18 offset:59392
    v_mfma_f32_32x32x16_bf16 v[88:103], v[60:63], v[48:51], v[88:103]
    ds_read_b128 v[28:31], v17 offset:36864
    ds_read_b64_tr_b16 v[36:37], v18 offset:58368
    ds_read_b64_tr_b16 v[38:39], v18 offset:60416
    v_mfma_f32_32x32x16_bf16 v[136:151], v[56:59], v[52:55], v[136:151]
    ds_read_b128 v[40:43], v14 offset:0
    ds_read_b64_tr_b16 v[248:249], v18 offset:0
    ds_read_b64_tr_b16 v[250:251], v18 offset:2048
    v_mfma_f32_32x32x16_bf16 v[152:167], v[60:63], v[52:55], v[152:167]
    ds_read_b128 v[44:47], v14 offset:4096
    ds_read_b64_tr_b16 v[252:253], v18 offset:1024
    ds_read_b64_tr_b16 v[254:255], v18 offset:3072
    v_mfma_f32_32x32x16_bf16 v[72:87], v[240:243], v[64:67], v[72:87]
    v_mfma_f32_32x32x16_bf16 v[88:103], v[244:247], v[64:67], v[88:103]
    v_mfma_f32_32x32x16_bf16 v[136:151], v[240:243], v[68:71], v[136:151]
    v_mfma_f32_32x32x16_bf16 v[152:167], v[244:247], v[68:71], v[152:167]
    s_waitcnt lgkmcnt(0)
    s_barrier
    v_mfma_f32_32x32x16_bf16 v[72:87], v[32:35], v[24:27], v[72:87]
    ds_read_b128 v[48:51], v15 offset:0
    ds_read_b64_tr_b16 v[56:57], v18 offset:8192
    ds_read_b64_tr_b16 v[58:59], v18 offset:10240
    v_mfma_f32_32x32x16_bf16 v[88:103], v[36:39], v[24:27], v[88:103]
    ds_read_b128 v[52:55], v15 offset:4096
    ds_read_b64_tr_b16 v[60:61], v18 offset:9216
    ds_read_b64_tr_b16 v[62:63], v18 offset:11264
    v_mfma_f32_32x32x16_bf16 v[136:151], v[32:35], v[28:31], v[136:151]
    ds_read_b128 v[64:67], v16 offset:0
    ds_read_b64_tr_b16 v[240:241], v18 offset:16384
    ds_read_b64_tr_b16 v[242:243], v18 offset:18432
    v_mfma_f32_32x32x16_bf16 v[152:167], v[36:39], v[28:31], v[152:167]
    ds_read_b128 v[68:71], v16 offset:4096
    ds_read_b64_tr_b16 v[244:245], v18 offset:17408
    ds_read_b64_tr_b16 v[246:247], v18 offset:19456
    v_mfma_f32_32x32x16_bf16 v[72:87], v[248:251], v[40:43], v[72:87]
    v_mfma_f32_32x32x16_bf16 v[88:103], v[252:255], v[40:43], v[88:103]
    v_mfma_f32_32x32x16_bf16 v[136:151], v[248:251], v[44:47], v[136:151]
    global_load_dword v0, v23, s[58:59] sc1
    v_mfma_f32_32x32x16_bf16 v[152:167], v[252:255], v[44:47], v[152:167]
    s_waitcnt lgkmcnt(0)
    v_mfma_f32_32x32x16_bf16 v[72:87], v[56:59], v[48:51], v[72:87]
    ds_read_b128 v[24:27], v17 offset:0
    ds_read_b64_tr_b16 v[32:33], v18 offset:24576
    ds_read_b64_tr_b16 v[34:35], v18 offset:26624
    v_mfma_f32_32x32x16_bf16 v[88:103], v[60:63], v[48:51], v[88:103]
    ds_read_b128 v[28:31], v17 offset:4096
    ds_read_b64_tr_b16 v[36:37], v18 offset:25600
    ds_read_b64_tr_b16 v[38:39], v18 offset:27648
    v_mfma_f32_32x32x16_bf16 v[136:151], v[56:59], v[52:55], v[136:151]
    ds_read_b128 v[40:43], v15 offset:32768
    ds_read_b64_tr_b16 v[248:249], v19 offset:40960
    ds_read_b64_tr_b16 v[250:251], v19 offset:43008
    v_mfma_f32_32x32x16_bf16 v[152:167], v[60:63], v[52:55], v[152:167]
    ds_read_b128 v[44:47], v15 offset:36864
    ds_read_b64_tr_b16 v[252:253], v19 offset:41984
    ds_read_b64_tr_b16 v[254:255], v19 offset:44032
    v_mfma_f32_32x32x16_bf16 v[72:87], v[240:243], v[64:67], v[72:87]
    v_mfma_f32_32x32x16_bf16 v[88:103], v[244:247], v[64:67], v[88:103]
    v_mfma_f32_32x32x16_bf16 v[136:151], v[240:243], v[68:71], v[136:151]
    v_mfma_f32_32x32x16_bf16 v[152:167], v[244:247], v[68:71], v[152:167]
    s_waitcnt lgkmcnt(0)
    v_mfma_f32_32x32x16_bf16 v[72:87], v[32:35], v[24:27], v[72:87]
    ds_read_b128 v[48:51], v16 offset:32768
    ds_read_b64_tr_b16 v[56:57], v19 offset:49152
    ds_read_b64_tr_b16 v[58:59], v19 offset:51200
    v_mfma_f32_32x32x16_bf16 v[88:103], v[36:39], v[24:27], v[88:103]
    ds_read_b128 v[52:55], v16 offset:36864
    ds_read_b64_tr_b16 v[60:61], v19 offset:50176
    ds_read_b64_tr_b16 v[62:63], v19 offset:52224
    v_mfma_f32_32x32x16_bf16 v[136:151], v[32:35], v[28:31], v[136:151]
    ds_read_b128 v[64:67], v17 offset:32768
    ds_read_b64_tr_b16 v[240:241], v19 offset:57344
    ds_read_b64_tr_b16 v[242:243], v19 offset:59392
    v_mfma_f32_32x32x16_bf16 v[152:167], v[36:39], v[28:31], v[152:167]
    ds_read_b128 v[68:71], v17 offset:36864
    ds_read_b64_tr_b16 v[244:245], v19 offset:58368
    ds_read_b64_tr_b16 v[246:247], v19 offset:60416
    v_mfma_f32_32x32x16_bf16 v[104:119], v[248:251], v[40:43], v[104:119]
    v_mfma_f32_32x32x16_bf16 v[120:135], v[252:255], v[40:43], v[120:135]
    v_mfma_f32_32x32x16_bf16 v[168:183], v[248:251], v[44:47], v[168:183]
    v_mul_f32 v72, s52, v72
    v_mul_f32 v73, s52, v73
    v_mul_f32 v74, s52, v74
    v_mul_f32 v75, s52, v75
    v_mul_f32 v76, s52, v76
    v_mul_f32 v77, s52, v77
    v_mul_f32 v78, s52, v78
    v_mfma_f32_32x32x16_bf16 v[184:199], v[252:255], v[44:47], v[184:199]
    v_mul_f32 v79, s52, v79
    v_exp_f32 v72, v72
    v_exp_f32 v73, v73
    v_exp_f32 v74, v74
    s_waitcnt lgkmcnt(0)
    v_mfma_f32_32x32x16_bf16 v[104:119], v[56:59], v[48:51], v[104:119]
    ds_read_b128 v[24:27], v14 offset:0
    ds_read_b64_tr_b16 v[32:33], v19 offset:0
    v_exp_f32 v75, v75
    v_exp_f32 v76, v76
    v_exp_f32 v77, v77
    v_exp_f32 v78, v78
    v_mfma_f32_32x32x16_bf16 v[120:135], v[60:63], v[48:51], v[120:135]
    ds_read_b64_tr_b16 v[34:35], v19 offset:2048
    ds_read_b128 v[28:31], v14 offset:4096
    v_exp_f32 v79, v79
    v_add_f32 v72, 1.0, v72
    v_add_f32 v73, 1.0, v73
    v_add_f32 v74, 1.0, v74
    v_add_f32 v75, 1.0, v75
    v_mfma_f32_32x32x16_bf16 v[168:183], v[56:59], v[52:55], v[168:183]
    ds_read_b64_tr_b16 v[36:37], v19 offset:1024
    ds_read_b64_tr_b16 v[38:39], v19 offset:3072
    v_add_f32 v76, 1.0, v76
    v_add_f32 v77, 1.0, v77
    v_add_f32 v78, 1.0, v78
    v_add_f32 v79, 1.0, v79
    v_rcp_f32 v72, v72
    v_rcp_f32 v73, v73
    v_mfma_f32_32x32x16_bf16 v[184:199], v[60:63], v[52:55], v[184:199]
    ds_read_b128 v[40:43], v15 offset:0
    ds_read_b64_tr_b16 v[248:249], v19 offset:8192
    v_rcp_f32 v74, v74
    v_rcp_f32 v75, v75
    v_rcp_f32 v76, v76
    v_mfma_f32_32x32x16_bf16 v[104:119], v[240:243], v[64:67], v[104:119]
    ds_read_b64_tr_b16 v[250:251], v19 offset:10240
    ds_read_b128 v[44:47], v15 offset:4096
    v_rcp_f32 v77, v77
    v_rcp_f32 v78, v78
    v_rcp_f32 v79, v79
    v_mul_f32 v72, v72, v88
    v_mfma_f32_32x32x16_bf16 v[120:135], v[244:247], v[64:67], v[120:135]
    ds_read_b64_tr_b16 v[252:253], v19 offset:9216
    ds_read_b64_tr_b16 v[254:255], v19 offset:11264
    v_mul_f32 v73, v73, v89
    v_mul_f32 v74, v74, v90
    v_mul_f32 v75, v75, v91
    v_mul_f32 v76, v76, v92
    v_mul_f32 v77, v77, v93
    v_mul_f32 v78, v78, v94
    v_mul_f32 v79, v79, v95
    v_mfma_f32_32x32x16_bf16 v[168:183], v[240:243], v[68:71], v[168:183]
    v_cvt_pk_bf16_f32 v72, v72, v73
    v_cvt_pk_bf16_f32 v73, v74, v75
    v_cvt_pk_bf16_f32 v74, v76, v77
    v_cvt_pk_bf16_f32 v75, v78, v79
    buffer_store_dwordx4 v[72:75], v20, s[24:27], s30 offen offset:0 sc1
    v_mul_f32 v80, s52, v80
    v_mul_f32 v81, s52, v81
    v_mfma_f32_32x32x16_bf16 v[184:199], v[244:247], v[68:71], v[184:199]
    v_mul_f32 v82, s52, v82
    v_mul_f32 v83, s52, v83
    v_mul_f32 v84, s52, v84
    v_mul_f32 v85, s52, v85
    v_mul_f32 v86, s52, v86
    v_mul_f32 v87, s52, v87
    v_exp_f32 v80, v80
    s_waitcnt lgkmcnt(0)
    v_mfma_f32_32x32x16_bf16 v[104:119], v[32:35], v[24:27], v[104:119]
    ds_read_b128 v[48:51], v16 offset:0
    ds_read_b64_tr_b16 v[56:57], v19 offset:16384
    v_exp_f32 v81, v81
    v_exp_f32 v82, v82
    v_exp_f32 v83, v83
    v_mfma_f32_32x32x16_bf16 v[120:135], v[36:39], v[24:27], v[120:135]
    ds_read_b64_tr_b16 v[58:59], v19 offset:18432
    ds_read_b128 v[52:55], v16 offset:4096
    v_exp_f32 v84, v84
    v_exp_f32 v85, v85
    v_exp_f32 v86, v86
    v_exp_f32 v87, v87
    v_mfma_f32_32x32x16_bf16 v[168:183], v[32:35], v[28:31], v[168:183]
    ds_read_b64_tr_b16 v[60:61], v19 offset:17408
    ds_read_b64_tr_b16 v[62:63], v19 offset:19456
    v_add_f32 v80, 1.0, v80
    v_add_f32 v81, 1.0, v81
    v_add_f32 v82, 1.0, v82
    v_add_f32 v83, 1.0, v83
    v_add_f32 v84, 1.0, v84
    v_add_f32 v85, 1.0, v85
    v_mfma_f32_32x32x16_bf16 v[184:199], v[36:39], v[28:31], v[184:199]
    ds_read_b128 v[64:67], v17 offset:0
    ds_read_b64_tr_b16 v[240:241], v19 offset:24576
    v_add_f32 v86, 1.0, v86
    v_add_f32 v87, 1.0, v87
    v_rcp_f32 v80, v80
    v_rcp_f32 v81, v81
    v_rcp_f32 v82, v82
    v_mfma_f32_32x32x16_bf16 v[104:119], v[248:251], v[40:43], v[104:119]
    ds_read_b64_tr_b16 v[242:243], v19 offset:26624
    ds_read_b128 v[68:71], v17 offset:4096
    v_rcp_f32 v83, v83
    v_rcp_f32 v84, v84
    v_rcp_f32 v85, v85
    v_mfma_f32_32x32x16_bf16 v[120:135], v[252:255], v[40:43], v[120:135]
    ds_read_b64_tr_b16 v[244:245], v19 offset:25600
    ds_read_b64_tr_b16 v[246:247], v19 offset:27648
    v_rcp_f32 v86, v86
    v_rcp_f32 v87, v87
    v_mul_f32 v80, v80, v96
    v_mul_f32 v81, v81, v97
    v_mul_f32 v82, v82, v98
    v_mul_f32 v83, v83, v99
    v_mfma_f32_32x32x16_bf16 v[168:183], v[248:251], v[44:47], v[168:183]
    v_mul_f32 v84, v84, v100
    v_mul_f32 v85, v85, v101
    v_mul_f32 v86, v86, v102
    v_mul_f32 v87, v87, v103
    v_cvt_pk_bf16_f32 v80, v80, v81
    v_cvt_pk_bf16_f32 v81, v82, v83
    v_cvt_pk_bf16_f32 v82, v84, v85
    v_mfma_f32_32x32x16_bf16 v[184:199], v[252:255], v[44:47], v[184:199]
    v_cvt_pk_bf16_f32 v83, v86, v87
    buffer_store_dwordx4 v[80:83], v20, s[24:27], s30 offen offset:1024 sc1
    v_mul_f32 v136, s52, v136
    v_mul_f32 v137, s52, v137
    v_mul_f32 v138, s52, v138
    v_mul_f32 v139, s52, v139
    v_mul_f32 v140, s52, v140
    s_waitcnt lgkmcnt(0)
    ds_write_b32 v3, v4
    v_mfma_f32_32x32x16_bf16 v[104:119], v[56:59], v[48:51], v[104:119]
    v_mul_f32 v141, s52, v141
    v_mul_f32 v142, s52, v142
    v_mul_f32 v143, s52, v143
    v_exp_f32 v136, v136
    v_exp_f32 v137, v137
    v_mfma_f32_32x32x16_bf16 v[120:135], v[60:63], v[48:51], v[120:135]
    v_exp_f32 v138, v138
    v_exp_f32 v139, v139
    v_exp_f32 v140, v140
    v_mfma_f32_32x32x16_bf16 v[168:183], v[56:59], v[52:55], v[168:183]
    v_exp_f32 v141, v141
    v_exp_f32 v142, v142
    v_exp_f32 v143, v143
    v_add_f32 v136, 1.0, v136
    v_add_f32 v137, 1.0, v137
    v_mfma_f32_32x32x16_bf16 v[184:199], v[60:63], v[52:55], v[184:199]
    v_add_f32 v138, 1.0, v138
    v_add_f32 v139, 1.0, v139
    v_add_f32 v140, 1.0, v140
    v_add_f32 v141, 1.0, v141
    v_add_f32 v142, 1.0, v142
    v_add_f32 v143, 1.0, v143
    v_mfma_f32_32x32x16_bf16 v[104:119], v[240:243], v[64:67], v[104:119]
    v_rcp_f32 v136, v136
    v_rcp_f32 v137, v137
    v_rcp_f32 v138, v138
    v_rcp_f32 v139, v139
    v_mfma_f32_32x32x16_bf16 v[120:135], v[244:247], v[64:67], v[120:135]
    v_rcp_f32 v140, v140
    v_rcp_f32 v141, v141
    v_rcp_f32 v142, v142
    v_mfma_f32_32x32x16_bf16 v[168:183], v[240:243], v[68:71], v[168:183]
    v_rcp_f32 v143, v143
    v_mul_f32 v136, v136, v152
    v_mul_f32 v137, v137, v153
    v_mul_f32 v138, v138, v154
    v_mul_f32 v139, v139, v155
    v_mul_f32 v140, v140, v156
    v_mul_f32 v141, v141, v157
    v_mfma_f32_32x32x16_bf16 v[184:199], v[244:247], v[68:71], v[184:199]
    v_mul_f32 v142, v142, v158
    v_mul_f32 v143, v143, v159
    v_cvt_pk_bf16_f32 v136, v136, v137
    v_cvt_pk_bf16_f32 v137, v138, v139
    v_cvt_pk_bf16_f32 v138, v140, v141
    v_cvt_pk_bf16_f32 v139, v142, v143
    buffer_store_dwordx4 v[136:139], v20, s[24:27], s31 offen offset:0 sc1
    v_mov_b32 v14, v6
    v_mov_b32 v15, v7
    ds_read_b128 v[16:19], v5
    v_mul_f32 v144, s52, v144
    v_mul_f32 v145, s52, v145
    v_mul_f32 v146, s52, v146
    v_mul_f32 v147, s52, v147
    v_mul_f32 v148, s52, v148
    v_mul_f32 v149, s52, v149
    v_mul_f32 v150, s52, v150
    v_mul_f32 v151, s52, v151
    v_exp_f32 v144, v144
    v_exp_f32 v145, v145
    v_exp_f32 v146, v146
    v_exp_f32 v147, v147
    v_exp_f32 v148, v148
    v_exp_f32 v149, v149
    v_exp_f32 v150, v150
    v_exp_f32 v151, v151
    s_waitcnt lgkmcnt(0)
    v_and_b32 v16, v16, v17
    v_and_b32 v18, v18, v19
    v_and_b32 v16, v16, v18
    v_cmp_ne_u32 vcc, 1, v16
    s_cbranch_vccnz A_ring_slow
A_ring_ok:
    s_add_u32 m0, s29, 0
    s_mul_i32 s61, s88, 14
    buffer_load_dwordx4 v8, s[44:47], s61 offen offset:0 lds
    v_add_f32 v144, 1.0, v144
    v_add_f32 v145, 1.0, v145
    v_add_f32 v146, 1.0, v146
    v_add_f32 v147, 1.0, v147
    v_add_f32 v148, 1.0, v148
    v_add_f32 v149, 1.0, v149
    v_add_f32 v150, 1.0, v150
    v_add_f32 v151, 1.0, v151
    v_rcp_f32 v144, v144
    v_rcp_f32 v145, v145
    v_rcp_f32 v146, v146
    v_rcp_f32 v147, v147
    v_rcp_f32 v148, v148
    v_rcp_f32 v149, v149
    v_rcp_f32 v150, v150
    v_rcp_f32 v151, v151
    buffer_load_dwordx4 v9, s[44:47], s61 offen offset:1024 lds
    v_mul_f32 v144, v144, v160
    v_mul_f32 v145, v145, v161
    v_mul_f32 v146, v146, v162
    v_mul_f32 v147, v147, v163
    v_mul_f32 v148, v148, v164
    v_mul_f32 v149, v149, v165
    v_mul_f32 v150, v150, v166
    v_mul_f32 v151, v151, v167
    v_cvt_pk_bf16_f32 v144, v144, v145
    v_cvt_pk_bf16_f32 v145, v146, v147
    v_cvt_pk_bf16_f32 v146, v148, v149
    v_cvt_pk_bf16_f32 v147, v150, v151
    buffer_store_dwordx4 v[144:147], v20, s[24:27], s31 offen offset:1024 sc1
    v_mul_f32 v104, s52, v104
    v_mul_f32 v105, s52, v105
    v_mul_f32 v106, s52, v106
    v_mul_f32 v107, s52, v107
    v_mul_f32 v108, s52, v108
    v_mul_f32 v109, s52, v109
    v_mul_f32 v110, s52, v110
    v_mul_f32 v111, s52, v111
    v_exp_f32 v104, v104
    v_exp_f32 v105, v105
    v_exp_f32 v106, v106
    v_exp_f32 v107, v107
    v_exp_f32 v108, v108
    v_exp_f32 v109, v109
    v_exp_f32 v110, v110
    v_exp_f32 v111, v111
    s_add_u32 m0, s29, 2048
    s_mul_i32 s61, s88, 14
    s_add_u32 s61, s61, 14336
    buffer_load_dwordx4 v8, s[44:47], s61 offen offset:0 lds
    v_add_f32 v104, 1.0, v104
    v_add_f32 v105, 1.0, v105
    v_add_f32 v106, 1.0, v106
    v_add_f32 v107, 1.0, v107
    v_add_f32 v108, 1.0, v108
    v_add_f32 v109, 1.0, v109
    v_add_f32 v110, 1.0, v110
    v_add_f32 v111, 1.0, v111
    v_rcp_f32 v104, v104
    v_rcp_f32 v105, v105
    v_rcp_f32 v106, v106
    v_rcp_f32 v107, v107
    v_rcp_f32 v108, v108
    v_rcp_f32 v109, v109
    v_rcp_f32 v110, v110
    v_rcp_f32 v111, v111
    buffer_load_dwordx4 v9, s[44:47], s61 offen offset:1024 lds
    v_mul_f32 v104, v104, v120
    v_mul_f32 v105, v105, v121
    v_mul_f32 v106, v106, v122
    v_mul_f32 v107, v107, v123
    v_mul_f32 v108, v108, v124
    v_mul_f32 v109, v109, v125
    v_mul_f32 v110, v110, v126
    v_mul_f32 v111, v111, v127
    v_cvt_pk_bf16_f32 v104, v104, v105
    v_cvt_pk_bf16_f32 v105, v106, v107
    v_cvt_pk_bf16_f32 v106, v108, v109
    v_cvt_pk_bf16_f32 v107, v110, v111
    buffer_store_dwordx4 v[104:107], v20, s[24:27], s30 offen offset:2048 sc1
    v_mul_f32 v112, s52, v112
    v_mul_f32 v113, s52, v113
    v_mul_f32 v114, s52, v114
    v_mul_f32 v115, s52, v115
    v_mul_f32 v116, s52, v116
    v_mul_f32 v117, s52, v117
    v_mul_f32 v118, s52, v118
    v_mul_f32 v119, s52, v119
    v_exp_f32 v112, v112
    v_exp_f32 v113, v113
    v_exp_f32 v114, v114
    v_exp_f32 v115, v115
    v_exp_f32 v116, v116
    v_exp_f32 v117, v117
    v_exp_f32 v118, v118
    v_exp_f32 v119, v119
    s_add_u32 m0, s29, 4096
    s_mul_i32 s61, s88, 14
    s_add_u32 s61, s61, 28672
    buffer_load_dwordx4 v8, s[44:47], s61 offen offset:0 lds
    v_add_f32 v112, 1.0, v112
    v_add_f32 v113, 1.0, v113
    v_add_f32 v114, 1.0, v114
    v_add_f32 v115, 1.0, v115
    v_add_f32 v116, 1.0, v116
    v_add_f32 v117, 1.0, v117
    v_add_f32 v118, 1.0, v118
    v_add_f32 v119, 1.0, v119
    v_rcp_f32 v112, v112
    v_rcp_f32 v113, v113
    v_rcp_f32 v114, v114
    v_rcp_f32 v115, v115
    v_rcp_f32 v116, v116
    v_rcp_f32 v117, v117
    v_rcp_f32 v118, v118
    v_rcp_f32 v119, v119
    buffer_load_dwordx4 v9, s[44:47], s61 offen offset:1024 lds
    v_mul_f32 v112, v112, v128
    v_mul_f32 v113, v113, v129
    v_mul_f32 v114, v114, v130
    v_mul_f32 v115, v115, v131
    v_mul_f32 v116, v116, v132
    v_mul_f32 v117, v117, v133
    v_mul_f32 v118, v118, v134
    v_mul_f32 v119, v119, v135
    v_cvt_pk_bf16_f32 v112, v112, v113
    v_cvt_pk_bf16_f32 v113, v114, v115
    v_cvt_pk_bf16_f32 v114, v116, v117
    v_cvt_pk_bf16_f32 v115, v118, v119
    buffer_store_dwordx4 v[112:115], v20, s[24:27], s30 offen offset:3072 sc1
    v_mul_f32 v168, s52, v168
    v_mul_f32 v169, s52, v169
    v_mul_f32 v170, s52, v170
    v_mul_f32 v171, s52, v171
    v_mul_f32 v172, s52, v172
    v_mul_f32 v173, s52, v173
    v_mul_f32 v174, s52, v174
    v_mul_f32 v175, s52, v175
    v_exp_f32 v168, v168
    v_exp_f32 v169, v169
    v_exp_f32 v170, v170
    v_exp_f32 v171, v171
    v_exp_f32 v172, v172
    v_exp_f32 v173, v173
    v_exp_f32 v174, v174
    v_exp_f32 v175, v175
    s_add_u32 m0, s29, 6144
    s_mul_i32 s61, s88, 14
    s_add_u32 s61, s61, 43008
    buffer_load_dwordx4 v8, s[44:47], s61 offen offset:0 lds
    v_add_f32 v168, 1.0, v168
    v_add_f32 v169, 1.0, v169
    v_add_f32 v170, 1.0, v170
    v_add_f32 v171, 1.0, v171
    v_add_f32 v172, 1.0, v172
    v_add_f32 v173, 1.0, v173
    v_add_f32 v174, 1.0, v174
    v_add_f32 v175, 1.0, v175
    v_rcp_f32 v168, v168
    v_rcp_f32 v169, v169
    v_rcp_f32 v170, v170
    v_rcp_f32 v171, v171
    v_rcp_f32 v172, v172
    v_rcp_f32 v173, v173
    v_rcp_f32 v174, v174
    v_rcp_f32 v175, v175
    buffer_load_dwordx4 v9, s[44:47], s61 offen offset:1024 lds
    v_mul_f32 v168, v168, v184
    v_mul_f32 v169, v169, v185
    v_mul_f32 v170, v170, v186
    v_mul_f32 v171, v171, v187
    v_mul_f32 v172, v172, v188
    v_mul_f32 v173, v173, v189
    v_mul_f32 v174, v174, v190
    v_mul_f32 v175, v175, v191
    v_cvt_pk_bf16_f32 v168, v168, v169
    v_cvt_pk_bf16_f32 v169, v170, v171
    v_cvt_pk_bf16_f32 v170, v172, v173
    v_cvt_pk_bf16_f32 v171, v174, v175
    buffer_store_dwordx4 v[168:171], v20, s[24:27], s31 offen offset:2048 sc1
    v_mul_f32 v176, s52, v176
    v_mul_f32 v177, s52, v177
    v_mul_f32 v178, s52, v178
    v_mul_f32 v179, s52, v179
    v_mul_f32 v180, s52, v180
    v_mul_f32 v181, s52, v181
    v_mul_f32 v182, s52, v182
    v_mul_f32 v183, s52, v183
    v_exp_f32 v176, v176
    v_exp_f32 v177, v177
    v_exp_f32 v178, v178
    v_exp_f32 v179, v179
    v_exp_f32 v180, v180
    v_exp_f32 v181, v181
    v_exp_f32 v182, v182
    v_exp_f32 v183, v183
    s_add_u32 m0, s29, 8192
    s_mul_i32 s61, s89, 14
    buffer_load_dwordx4 v8, s[44:47], s61 offen offset:0 lds
    v_add_f32 v176, 1.0, v176
    v_add_f32 v177, 1.0, v177
    v_add_f32 v178, 1.0, v178
    v_add_f32 v179, 1.0, v179
    v_add_f32 v180, 1.0, v180
    v_add_f32 v181, 1.0, v181
    v_add_f32 v182, 1.0, v182
    v_add_f32 v183, 1.0, v183
    v_rcp_f32 v176, v176
    v_rcp_f32 v177, v177
    v_rcp_f32 v178, v178
    v_rcp_f32 v179, v179
    v_rcp_f32 v180, v180
    v_rcp_f32 v181, v181
    v_rcp_f32 v182, v182
    v_rcp_f32 v183, v183
    buffer_load_dwordx4 v9, s[44:47], s61 offen offset:1024 lds
    v_mul_f32 v176, v176, v192
    v_mul_f32 v177, v177, v193
    v_mul_f32 v178, v178, v194
    v_mul_f32 v179, v179, v195
    v_mul_f32 v180, v180, v196
    v_mul_f32 v181, v181, v197
    v_mul_f32 v182, v182, v198
    v_mul_f32 v183, v183, v199
    v_cvt_pk_bf16_f32 v176, v176, v177
    v_cvt_pk_bf16_f32 v177, v178, v179
    v_cvt_pk_bf16_f32 v178, v180, v181
    v_cvt_pk_bf16_f32 v179, v182, v183
    buffer_store_dwordx4 v[176:179], v20, s[24:27], s31 offen offset:3072 sc1
    s_setprio 2
    s_add_u32 m0, s29, 10240
    s_mul_i32 s61, s89, 14
    s_add_u32 s61, s61, 14336
    buffer_load_dwordx4 v8, s[44:47], s61 offen offset:0 lds
    buffer_load_dwordx4 v9, s[44:47], s61 offen offset:1024 lds
    s_add_u32 m0, s29, 12288
    s_mul_i32 s61, s89, 14
    s_add_u32 s61, s61, 28672
    buffer_load_dwordx4 v8, s[44:47], s61 offen offset:0 lds
    buffer_load_dwordx4 v9, s[44:47], s61 offen offset:1024 lds
    s_add_u32 m0, s29, 14336
    s_mul_i32 s61, s89, 14
    s_add_u32 s61, s61, 43008
    buffer_load_dwordx4 v8, s[44:47], s61 offen offset:0 lds
    buffer_load_dwordx4 v9, s[44:47], s61 offen offset:1024 lds
    s_add_u32 m0, s60, 0
    s_mul_i32 s61, s90, 14
    buffer_load_dwordx4 v8, s[44:47], s61 offen offset:0 lds
    buffer_load_dwordx4 v9, s[44:47], s61 offen offset:1024 lds
    s_waitcnt vmcnt(26)
    v_readfirstlane_b32 s62, v0
    s_cmp_eq_u32 s62, 0
    s_cbranch_scc1 A_tag_slow
A_tag_ok:
    s_lshl_b32 s34, s32, 1
    s_add_u32 s34, s34, s37
    s_mul_i32 s34, s34, 28
    s_lshl_b32 s35, s33, 1
    s_add_u32 s35, s35, s36
    s_add_u32 s35, s35, s34
    s_lshl_b32 s35, s35, 7
    s_add_u32 s35, s35, 4096
    v_min_u32 v6, 6, v2
    v_lshlrev_b32 v6, 7, v6
    s_mul_i32 s34, s39, 4
    s_add_u32 s34, s34, s28
    s_mul_i32 s34, s34, 896
    s_add_u32 s34, s34, 4096
    v_add_u32 v6, s34, v6
    v_mov_b32 v7, s62
    v_add_u32 v5, s35, v20
    v_mov_b32 v68, s62
    v_mov_b32 v69, s62
    v_mov_b32 v70, s62
    v_mov_b32 v71, s62
    s_add_u32 s12, s6, 10780672
    s_addc_u32 s13, s7, 0
    s_mov_b32 s14, 1835008
    s_mov_b32 s15, 0x20000
    s_add_u32 s16, s6, 20070400
    s_addc_u32 s17, s7, 0
    s_mov_b32 s18, 8192
    s_mov_b32 s19, 0x20000
    s_mov_b32 s20, s56
    s_mov_b32 s21, s57
    s_mov_b32 s22, 1835008
    s_mov_b32 s23, 0x20000
    s_lshl_b32 s42, s40, 1
    s_add_u32 s42, s42, s36
    s_lshl_b32 s43, s39, 1
    s_add_u32 s43, s43, s37
    s_lshr_b32 s34, s43, 5
    s_mul_i32 s34, s34, 448
    s_lshl_b32 s52, s42, 5
    s_add_u32 s34, s34, s52
    s_lshl_b32 s34, s34, 7
    s_add_u32 s34, s34, 118784
    v_lshlrev_b32 v12, 7, v2
    v_add_u32 v12, s34, v12
    s_lshl_b32 s34, s39, 7
    v_mov_b32 v13, s34
    v_cmp_gt_u32 vcc, 32, v2
    v_and_b32 v3, 3, v2
    s_nop 0
    v_cndmask_b32 v12, v13, v12, vcc
    v_lshrrev_b32 v13, 2, v2
    v_lshlrev_b32 v13, 12, v13
    v_lshl_add_u32 v13, v3, 4, v13
    s_lshl_b32 s52, s42, 17
    s_lshl_b32 s34, s43, 6
    s_add_u32 s52, s52, s34
    s_add_u32 s53, s52, 65536
    v_and_b32 v1, 31, v2
    v_lshlrev_b32 v16, 2, v1
    s_lshl_b32 s54, s43, 7
    v_lshrrev_b32 v0, 5, v2
    v_bfe_u32 v4, v2, 2, 2
    v_lshl_add_u32 v4, v0, 2, v4
    v_lshlrev_b32 v4, 6, v4
    v_mul_u32_u24 v1, 896, v1
    v_lshl_add_u32 v1, v0, 4, v1
    v_bfe_u32 v0, v2, 4, 1
    v_lshl_add_u32 v4, v0, 5, v4
    v_lshl_add_u32 v0, v3, 3, v4
    v_add_u32 v0, s29, v0
    s_xor_b32 s34, s28, 1
    s_mul_i32 s34, s34, 16384
    v_add_u32 v4, s34, v20
    s_xor_b32 s34, s28, 2
    s_mul_i32 s34, s34, 16384
    v_add_u32 v19, s34, v20
    s_xor_b32 s34, s28, 3
    s_mul_i32 s34, s34, 16384
    v_add_u32 v23, s34, v20
    s_mul_i32 s55, s43, 28672
    s_lshl_b32 s34, s42, 6
    s_add_u32 s55, s55, s34
    v_add_u32 v17, s29, v20
    s_waitcnt vmcnt(8)
    s_mov_b64 exec, 255
    buffer_store_dwordx4 v[68:71], v5, s[48:51], 0 offen sc1
    s_mov_b64 exec, -1
    s_add_u32 m0, s60, 2048
    s_mul_i32 s61, s90, 14
    s_add_u32 s61, s61, 14336
    buffer_load_dwordx4 v8, s[44:47], s61 offen offset:0 lds
    buffer_load_dwordx4 v9, s[44:47], s61 offen offset:1024 lds
    ds_read_b64_tr_b16 v[200:201], v21 offset:0
    ds_read_b64_tr_b16 v[202:203], v21 offset:1024
    ds_read_b64_tr_b16 v[204:205], v22 offset:0
    ds_read_b64_tr_b16 v[206:207], v22 offset:1024
    s_add_u32 m0, s60, 4096
    s_mul_i32 s61, s90, 14
    s_add_u32 s61, s61, 28672
    buffer_load_dwordx4 v8, s[44:47], s61 offen offset:0 lds
    buffer_load_dwordx4 v9, s[44:47], s61 offen offset:1024 lds
    ds_read_b64_tr_b16 v[208:209], v21 offset:2048
    ds_read_b64_tr_b16 v[210:211], v21 offset:3072
    ds_read_b64_tr_b16 v[212:213], v22 offset:2048
    ds_read_b64_tr_b16 v[214:215], v22 offset:3072
    s_add_u32 m0, s60, 6144
    s_mul_i32 s61, s90, 14
    s_add_u32 s61, s61, 43008
    buffer_load_dwordx4 v8, s[44:47], s61 offen offset:0 lds
    buffer_load_dwordx4 v9, s[44:47], s61 offen offset:1024 lds
    ds_read_b64_tr_b16 v[216:217], v21 offset:4096
    ds_read_b64_tr_b16 v[218:219], v21 offset:5120
    ds_read_b64_tr_b16 v[220:221], v22 offset:4096
    ds_read_b64_tr_b16 v[222:223], v22 offset:5120
    s_waitcnt lgkmcnt(4)
    s_add_u32 m0, s29, 0
    s_mul_i32 s61, s91, 14
    buffer_load_dwordx4 v8, s[44:47], s61 offen offset:0 lds
    buffer_load_dwordx4 v9, s[44:47], s61 offen offset:1024 lds
    s_add_u32 m0, s29, 2048
    s_mul_i32 s61, s91, 14
    s_add_u32 s61, s61, 14336
    buffer_load_dwordx4 v8, s[44:47], s61 offen offset:0 lds
    buffer_load_dwordx4 v9, s[44:47], s61 offen offset:1024 lds
    ds_read_b64_tr_b16 v[224:225], v21 offset:6144
    ds_read_b64_tr_b16 v[226:227], v21 offset:7168
    ds_read_b64_tr_b16 v[228:229], v22 offset:6144
    ds_read_b64_tr_b16 v[230:231], v22 offset:7168
    s_waitcnt lgkmcnt(4)
    s_add_u32 m0, s29, 4096
    s_mul_i32 s61, s91, 14
    s_add_u32 s61, s61, 28672
    buffer_load_dwordx4 v8, s[44:47], s61 offen offset:0 lds
    buffer_load_dwordx4 v9, s[44:47], s61 offen offset:1024 lds
    ds_read_b64_tr_b16 v[232:233], v21 offset:8192
    ds_read_b64_tr_b16 v[234:235], v21 offset:9216
    ds_read_b64_tr_b16 v[236:237], v22 offset:8192
    ds_read_b64_tr_b16 v[238:239], v22 offset:9216
    s_waitcnt lgkmcnt(4)
    s_add_u32 m0, s29, 6144
    s_mul_i32 s61, s91, 14
    s_add_u32 s61, s61, 43008
    buffer_load_dwordx4 v8, s[44:47], s61 offen offset:0 lds
    buffer_load_dwordx4 v9, s[44:47], s61 offen offset:1024 lds
    s_waitcnt vmcnt(21)
    ds_read_b64_tr_b16 v[240:241], v21 offset:10240
    ds_read_b64_tr_b16 v[242:243], v21 offset:11264
    ds_read_b64_tr_b16 v[244:245], v22 offset:10240
    ds_read_b64_tr_b16 v[246:247], v22 offset:11264
    s_waitcnt lgkmcnt(4)
    s_add_u32 m0, s29, 8192
    s_mul_i32 s61, s92, 14
    buffer_load_dwordx4 v8, s[44:47], s61 offen offset:0 lds
    buffer_load_dwordx4 v9, s[44:47], s61 offen offset:1024 lds
    s_waitcnt vmcnt(21)
    ds_read_b64_tr_b16 v[248:249], v21 offset:12288
    ds_read_b64_tr_b16 v[250:251], v21 offset:13312
    ds_read_b64_tr_b16 v[252:253], v22 offset:12288
    ds_read_b64_tr_b16 v[254:255], v22 offset:13312
    s_waitcnt lgkmcnt(4)
    s_add_u32 m0, s29, 10240
    s_mul_i32 s61, s92, 14
    s_add_u32 s61, s61, 14336
    buffer_load_dwordx4 v8, s[44:47], s61 offen offset:0 lds
    buffer_load_dwordx4 v9, s[44:47], s61 offen offset:1024 lds
    s_waitcnt vmcnt(21)
    ds_read_b64_tr_b16 v[24:25], v21 offset:14336
    ds_read_b64_tr_b16 v[26:27], v21 offset:15360
    ds_read_b64_tr_b16 v[28:29], v22 offset:14336
    ds_read_b64_tr_b16 v[30:31], v22 offset:15360
    s_waitcnt lgkmcnt(4)
    s_add_u32 m0, s29, 12288
    s_mul_i32 s61, s92, 14
    s_add_u32 s61, s61, 28672
    buffer_load_dwordx4 v8, s[44:47], s61 offen offset:0 lds
    buffer_load_dwordx4 v9, s[44:47], s61 offen offset:1024 lds
    s_waitcnt vmcnt(21)
    ds_read_b64_tr_b16 v[32:33], v14 offset:0
    ds_read_b64_tr_b16 v[34:35], v14 offset:1024
    ds_read_b64_tr_b16 v[36:37], v15 offset:0
    ds_read_b64_tr_b16 v[38:39], v15 offset:1024
    s_waitcnt lgkmcnt(4)
    s_add_u32 m0, s29, 14336
    s_mul_i32 s61, s92, 14
    s_add_u32 s61, s61, 43008
    buffer_load_dwordx4 v8, s[44:47], s61 offen offset:0 lds
    buffer_load_dwordx4 v9, s[44:47], s61 offen offset:1024 lds
    s_waitcnt vmcnt(20)
    ds_read_b64_tr_b16 v[40:41], v14 offset:2048
    ds_read_b64_tr_b16 v[42:43], v14 offset:3072
    ds_read_b64_tr_b16 v[44:45], v15 offset:2048
    ds_read_b64_tr_b16 v[46:47], v15 offset:3072
    s_waitcnt lgkmcnt(4)
    buffer_load_dword v7, v6, s[48:51], 0 offen sc1
    s_add_u32 m0, s60, 0
    s_mul_i32 s61, s93, 14
    buffer_load_dwordx4 v8, s[44:47], s61 offen offset:0 lds
    buffer_load_dwordx4 v9, s[44:47], s61 offen offset:1024 lds
    s_waitcnt vmcnt(21)
    ds_read_b64_tr_b16 v[48:49], v14 offset:4096
    ds_read_b64_tr_b16 v[50:51], v14 offset:5120
    ds_read_b64_tr_b16 v[52:53], v15 offset:4096
    ds_read_b64_tr_b16 v[54:55], v15 offset:5120
    s_waitcnt lgkmcnt(4)
    s_add_u32 m0, s60, 2048
    s_mul_i32 s61, s93, 14
    s_add_u32 s61, s61, 14336
    buffer_load_dwordx4 v8, s[44:47], s61 offen offset:0 lds
    buffer_load_dwordx4 v9, s[44:47], s61 offen offset:1024 lds
    s_waitcnt vmcnt(21)
    ds_read_b64_tr_b16 v[56:57], v14 offset:6144
    ds_read_b64_tr_b16 v[58:59], v14 offset:7168
    ds_read_b64_tr_b16 v[60:61], v15 offset:6144
    ds_read_b64_tr_b16 v[62:63], v15 offset:7168
    s_waitcnt lgkmcnt(4)
    s_add_u32 m0, s60, 4096
    s_mul_i32 s61, s93, 14
    s_add_u32 s61, s61, 28672
    buffer_load_dwordx4 v8, s[44:47], s61 offen offset:0 lds
    buffer_load_dwordx4 v9, s[44:47], s61 offen offset:1024 lds
    s_waitcnt lgkmcnt(0)
    s_add_u32 m0, s60, 6144
    s_mul_i32 s61, s93, 14
    s_add_u32 s61, s61, 43008
    buffer_load_dwordx4 v8, s[44:47], s61 offen offset:0 lds
    buffer_load_dwordx4 v9, s[44:47], s61 offen offset:1024 lds
    s_mov_b64 exec, 7
    s_waitcnt vmcnt(8)
    v_cmp_ne_u32 vcc, s62, v7
    s_cbranch_vccnz A_ph_slow
A_ph_ok:
    s_mov_b64 exec, -1
    buffer_load_dwordx4 v[64:67], v10, s[24:27], s88 offen offset:0 sc1
    buffer_load_dwordx4 v[68:71], v11, s[24:27], s88 offen offset:0 sc1
    buffer_load_dwordx4 v[136:139], v10, s[24:27], s88 offen offset:1024 sc1
    buffer_load_dwordx4 v[140:143], v11, s[24:27], s88 offen offset:1024 sc1
    buffer_load_dwordx4 v[144:147], v10, s[24:27], s88 offen offset:2048 sc1
    buffer_load_dwordx4 v[148:151], v11, s[24:27], s88 offen offset:2048 sc1
    buffer_load_dwordx4 v[152:155], v10, s[24:27], s88 offen offset:3072 sc1
    buffer_load_dwordx4 v[156:159], v11, s[24:27], s88 offen offset:3072 sc1
    buffer_load_dword v7, v6, s[48:51], 0 offen sc1
    buffer_load_dwordx4 v[160:163], v10, s[24:27], s89 offen offset:0 sc1
    buffer_load_dwordx4 v[164:167], v11, s[24:27], s89 offen offset:0 sc1
    buffer_load_dwordx4 v[168:171], v10, s[24:27], s89 offen offset:1024 sc1
    buffer_load_dwordx4 v[172:175], v11, s[24:27], s89 offen offset:1024 sc1
    buffer_load_dwordx4 v[176:179], v10, s[24:27], s89 offen offset:2048 sc1
    s_setprio 0
    s_waitcnt vmcnt(12) lgkmcnt(0)
    v_mfma_f32_32x32x16_bf16 v[72:87], v[200:203], v[64:67], 0
    buffer_load_dwordx4 v[180:183], v11, s[24:27], s89 offen offset:2048 sc1
    v_mfma_f32_32x32x16_bf16 v[88:103], v[200:203], v[68:71], 0
    buffer_load_dwordx4 v[184:187], v10, s[24:27], s89 offen offset:3072 sc1
    v_mfma_f32_32x32x16_bf16 v[120:135], v[204:207], v[68:71], 0
    v_mfma_f32_32x32x16_bf16 v[104:119], v[204:207], v[64:67], 0
    s_waitcnt vmcnt(12)
    v_mfma_f32_32x32x16_bf16 v[72:87], v[208:211], v[136:139], v[72:87]
    ds_read_b64_tr_b16 v[200:201], v21 offset:0
    buffer_load_dwordx4 v[188:191], v11, s[24:27], s89 offen offset:3072 sc1
    v_mfma_f32_32x32x16_bf16 v[88:103], v[208:211], v[140:143], v[88:103]
    ds_read_b64_tr_b16 v[202:203], v21 offset:1024
    buffer_load_dwordx4 v[192:195], v10, s[24:27], s90 offen offset:0 sc1
    v_mfma_f32_32x32x16_bf16 v[120:135], v[212:215], v[140:143], v[120:135]
    ds_read_b64_tr_b16 v[204:205], v22 offset:0
    v_mfma_f32_32x32x16_bf16 v[104:119], v[212:215], v[136:139], v[104:119]
    ds_read_b64_tr_b16 v[206:207], v22 offset:1024
    s_waitcnt vmcnt(12)
    v_mfma_f32_32x32x16_bf16 v[72:87], v[216:219], v[144:147], v[72:87]
    ds_read_b64_tr_b16 v[208:209], v21 offset:2048
    buffer_load_dwordx4 v[196:199], v11, s[24:27], s90 offen offset:0 sc1
    v_mfma_f32_32x32x16_bf16 v[88:103], v[216:219], v[148:151], v[88:103]
    ds_read_b64_tr_b16 v[210:211], v21 offset:3072
    buffer_load_dwordx4 v[64:67], v10, s[24:27], s90 offen offset:1024 sc1
    v_mfma_f32_32x32x16_bf16 v[120:135], v[220:223], v[148:151], v[120:135]
    ds_read_b64_tr_b16 v[212:213], v22 offset:2048
    v_mfma_f32_32x32x16_bf16 v[104:119], v[220:223], v[144:147], v[104:119]
    ds_read_b64_tr_b16 v[214:215], v22 offset:3072
    s_waitcnt vmcnt(12) lgkmcnt(4)
    v_mfma_f32_32x32x16_bf16 v[72:87], v[224:227], v[152:155], v[72:87]
    ds_read_b64_tr_b16 v[216:217], v21 offset:4096
    buffer_load_dwordx4 v[68:71], v11, s[24:27], s90 offen offset:1024 sc1
    v_mfma_f32_32x32x16_bf16 v[88:103], v[224:227], v[156:159], v[88:103]
    ds_read_b64_tr_b16 v[218:219], v21 offset:5120
    buffer_load_dwordx4 v[136:139], v10, s[24:27], s90 offen offset:2048 sc1
    v_mfma_f32_32x32x16_bf16 v[120:135], v[228:231], v[156:159], v[120:135]
    ds_read_b64_tr_b16 v[220:221], v22 offset:4096
    v_mfma_f32_32x32x16_bf16 v[104:119], v[228:231], v[152:155], v[104:119]
    ds_read_b64_tr_b16 v[222:223], v22 offset:5120
    s_waitcnt vmcnt(13)
    v_cmp_ne_u32 vcc, s62, v7
    s_cbranch_vccnz A_ph2_slow
A_ph2_ok:
    s_add_u32 m0, s29, 0
    s_mul_i32 s61, s94, 14
    buffer_load_dwordx4 v8, s[44:47], s61 offen offset:0 lds
    s_waitcnt vmcnt(12) lgkmcnt(4)
    v_mfma_f32_32x32x16_bf16 v[72:87], v[232:235], v[160:163], v[72:87]
    ds_read_b64_tr_b16 v[224:225], v21 offset:6144
    buffer_load_dwordx4 v9, s[44:47], s61 offen offset:1024 lds
    v_mfma_f32_32x32x16_bf16 v[88:103], v[232:235], v[164:167], v[88:103]
    ds_read_b64_tr_b16 v[226:227], v21 offset:7168
    buffer_load_dwordx4 v[140:143], v11, s[24:27], s90 offen offset:2048 sc1
    v_mfma_f32_32x32x16_bf16 v[120:135], v[236:239], v[164:167], v[120:135]
    ds_read_b64_tr_b16 v[228:229], v22 offset:6144
    v_mfma_f32_32x32x16_bf16 v[104:119], v[236:239], v[160:163], v[104:119]
    ds_read_b64_tr_b16 v[230:231], v22 offset:7168
    s_waitcnt vmcnt(12) lgkmcnt(4)
    v_mfma_f32_32x32x16_bf16 v[72:87], v[240:243], v[168:171], v[72:87]
    ds_read_b64_tr_b16 v[232:233], v21 offset:8192
    s_add_u32 m0, s29, 2048
    s_mul_i32 s61, s94, 14
    s_add_u32 s61, s61, 14336
    buffer_load_dwordx4 v8, s[44:47], s61 offen offset:0 lds
    v_mfma_f32_32x32x16_bf16 v[88:103], v[240:243], v[172:175], v[88:103]
    ds_read_b64_tr_b16 v[234:235], v21 offset:9216
    buffer_load_dwordx4 v9, s[44:47], s61 offen offset:1024 lds
    v_mfma_f32_32x32x16_bf16 v[120:135], v[244:247], v[172:175], v[120:135]
    ds_read_b64_tr_b16 v[236:237], v22 offset:8192
    v_mfma_f32_32x32x16_bf16 v[104:119], v[244:247], v[168:171], v[104:119]
    ds_read_b64_tr_b16 v[238:239], v22 offset:9216
    s_waitcnt vmcnt(12) lgkmcnt(4)
    v_mfma_f32_32x32x16_bf16 v[72:87], v[248:251], v[176:179], v[72:87]
    ds_read_b64_tr_b16 v[240:241], v21 offset:10240
    s_add_u32 m0, s29, 4096
    s_mul_i32 s61, s94, 14
    s_add_u32 s61, s61, 28672
    buffer_load_dwordx4 v8, s[44:47], s61 offen offset:0 lds
    v_mfma_f32_32x32x16_bf16 v[88:103], v[248:251], v[180:183], v[88:103]
    ds_read_b64_tr_b16 v[242:243], v21 offset:11264
    buffer_load_dwordx4 v9, s[44:47], s61 offen offset:1024 lds
    v_mfma_f32_32x32x16_bf16 v[120:135], v[252:255], v[180:183], v[120:135]
    ds_read_b64_tr_b16 v[244:245], v22 offset:10240
    v_mfma_f32_32x32x16_bf16 v[104:119], v[252:255], v[176:179], v[104:119]
    ds_read_b64_tr_b16 v[246:247], v22 offset:11264
    s_waitcnt vmcnt(12) lgkmcnt(4)
    v_mfma_f32_32x32x16_bf16 v[72:87], v[24:27], v[184:187], v[72:87]
    ds_read_b64_tr_b16 v[248:249], v21 offset:12288
    s_add_u32 m0, s29, 6144
    s_mul_i32 s61, s94, 14
    s_add_u32 s61, s61, 43008
    buffer_load_dwordx4 v8, s[44:47], s61 offen offset:0 lds
    v_mfma_f32_32x32x16_bf16 v[88:103], v[24:27], v[188:191], v[88:103]
    ds_read_b64_tr_b16 v[250:251], v21 offset:13312
    buffer_load_dwordx4 v9, s[44:47], s61 offen offset:1024 lds
    v_mfma_f32_32x32x16_bf16 v[120:135], v[28:31], v[188:191], v[120:135]
    ds_read_b64_tr_b16 v[252:253], v22 offset:12288
    v_mfma_f32_32x32x16_bf16 v[104:119], v[28:31], v[184:187], v[104:119]
    ds_read_b64_tr_b16 v[254:255], v22 offset:13312
    s_waitcnt vmcnt(12) lgkmcnt(4)
    v_mfma_f32_32x32x16_bf16 v[72:87], v[32:35], v[192:195], v[72:87]
    ds_read_b64_tr_b16 v[24:25], v21 offset:14336
    buffer_load_dwordx4 v[144:147], v10, s[24:27], s90 offen offset:3072 sc1
    v_mfma_f32_32x32x16_bf16 v[88:103], v[32:35], v[196:199], v[88:103]
    ds_read_b64_tr_b16 v[26:27], v21 offset:15360
    buffer_load_dwordx4 v[148:151], v11, s[24:27], s90 offen offset:3072 sc1
    v_mfma_f32_32x32x16_bf16 v[120:135], v[36:39], v[196:199], v[120:135]
    ds_read_b64_tr_b16 v[28:29], v22 offset:14336
    v_mfma_f32_32x32x16_bf16 v[104:119], v[36:39], v[192:195], v[104:119]
    ds_read_b64_tr_b16 v[30:31], v22 offset:15360
    s_waitcnt vmcnt(12) lgkmcnt(4)
    v_mfma_f32_32x32x16_bf16 v[72:87], v[40:43], v[64:67], v[72:87]
    ds_read_b64_tr_b16 v[32:33], v14 offset:0
    buffer_load_dwordx4 v[152:155], v10, s[24:27], s91 offen offset:0 sc1
    v_mfma_f32_32x32x16_bf16 v[88:103], v[40:43], v[68:71], v[88:103]
    ds_read_b64_tr_b16 v[34:35], v14 offset:1024
    buffer_load_dwordx4 v[156:159], v11, s[24:27], s91 offen offset:0 sc1
    v_mfma_f32_32x32x16_bf16 v[120:135], v[44:47], v[68:71], v[120:135]
    ds_read_b64_tr_b16 v[36:37], v15 offset:0
    v_mfma_f32_32x32x16_bf16 v[104:119], v[44:47], v[64:67], v[104:119]
    ds_read_b64_tr_b16 v[38:39], v15 offset:1024
    s_waitcnt vmcnt(10) lgkmcnt(4)
    v_mfma_f32_32x32x16_bf16 v[72:87], v[48:51], v[136:139], v[72:87]
    ds_read_b64_tr_b16 v[40:41], v14 offset:2048
    buffer_load_dwordx4 v[160:163], v10, s[24:27], s91 offen offset:1024 sc1
    v_mfma_f32_32x32x16_bf16 v[88:103], v[48:51], v[140:143], v[88:103]
    ds_read_b64_tr_b16 v[42:43], v14 offset:3072
    buffer_load_dwordx4 v[164:167], v11, s[24:27], s91 offen offset:1024 sc1
    v_mfma_f32_32x32x16_bf16 v[120:135], v[52:55], v[140:143], v[120:135]
    ds_read_b64_tr_b16 v[44:45], v15 offset:2048
    buffer_load_dwordx4 v[168:171], v10, s[24:27], s91 offen offset:2048 sc1
    v_mfma_f32_32x32x16_bf16 v[104:119], v[52:55], v[136:139], v[104:119]
    ds_read_b64_tr_b16 v[46:47], v15 offset:3072
    buffer_load_dwordx4 v[172:175], v11, s[24:27], s91 offen offset:2048 sc1
    s_waitcnt vmcnt(6) lgkmcnt(4)
    v_mfma_f32_32x32x16_bf16 v[72:87], v[56:59], v[144:147], v[72:87]
    ds_read_b64_tr_b16 v[48:49], v14 offset:4096
    buffer_load_dwordx4 v[176:179], v10, s[24:27], s91 offen offset:3072 sc1
    v_mfma_f32_32x32x16_bf16 v[88:103], v[56:59], v[148:151], v[88:103]
    ds_read_b64_tr_b16 v[50:51], v14 offset:5120
    buffer_load_dwordx4 v[180:183], v11, s[24:27], s91 offen offset:3072 sc1
    v_mfma_f32_32x32x16_bf16 v[120:135], v[60:63], v[148:151], v[120:135]
    ds_read_b64_tr_b16 v[52:53], v15 offset:4096
    buffer_load_dwordx4 v[184:187], v10, s[24:27], s92 offen offset:0 sc1
    v_mfma_f32_32x32x16_bf16 v[104:119], v[60:63], v[144:147], v[104:119]
    ds_read_b64_tr_b16 v[54:55], v15 offset:5120
    buffer_load_dwordx4 v[188:191], v11, s[24:27], s92 offen offset:0 sc1
    s_waitcnt vmcnt(8) lgkmcnt(4)
    v_mfma_f32_32x32x16_bf16 v[72:87], v[200:203], v[152:155], v[72:87]
    ds_read_b64_tr_b16 v[56:57], v14 offset:6144
    buffer_load_dwordx4 v[192:195], v10, s[24:27], s92 offen offset:1024 sc1
    v_mfma_f32_32x32x16_bf16 v[88:103], v[200:203], v[156:159], v[88:103]
    ds_read_b64_tr_b16 v[58:59], v14 offset:7168
    buffer_load_dwordx4 v[196:199], v11, s[24:27], s92 offen offset:1024 sc1
    v_mfma_f32_32x32x16_bf16 v[120:135], v[204:207], v[156:159], v[120:135]
    ds_read_b64_tr_b16 v[60:61], v15 offset:6144
    buffer_load_dwordx4 v[64:67], v10, s[24:27], s92 offen offset:2048 sc1
    v_mfma_f32_32x32x16_bf16 v[104:119], v[204:207], v[152:155], v[104:119]
    ds_read_b64_tr_b16 v[62:63], v15 offset:7168
    buffer_load_dwordx4 v[68:71], v11, s[24:27], s92 offen offset:2048 sc1
    s_waitcnt vmcnt(10) lgkmcnt(4)
    v_mfma_f32_32x32x16_bf16 v[72:87], v[208:211], v[160:163], v[72:87]
    ds_read_b64_tr_b16 v[200:201], v21 offset:0
    buffer_load_dwordx4 v[136:139], v10, s[24:27], s92 offen offset:3072 sc1
    v_mfma_f32_32x32x16_bf16 v[88:103], v[208:211], v[164:167], v[88:103]
    ds_read_b64_tr_b16 v[202:203], v21 offset:1024
    buffer_load_dwordx4 v[140:143], v11, s[24:27], s92 offen offset:3072 sc1
    v_mfma_f32_32x32x16_bf16 v[120:135], v[212:215], v[164:167], v[120:135]
    ds_read_b64_tr_b16 v[204:205], v22 offset:0
    buffer_load_dwordx4 v[144:147], v10, s[24:27], s93 offen offset:0 sc1
    v_mfma_f32_32x32x16_bf16 v[104:119], v[212:215], v[160:163], v[104:119]
    ds_read_b64_tr_b16 v[206:207], v22 offset:1024
    buffer_load_dwordx4 v[148:151], v11, s[24:27], s93 offen offset:0 sc1
    s_waitcnt vmcnt(12) lgkmcnt(4)
    v_mfma_f32_32x32x16_bf16 v[72:87], v[216:219], v[168:171], v[72:87]
    ds_read_b64_tr_b16 v[208:209], v21 offset:2048
    buffer_load_dwordx4 v[152:155], v10, s[24:27], s93 offen offset:1024 sc1
    v_mfma_f32_32x32x16_bf16 v[88:103], v[216:219], v[172:175], v[88:103]
    ds_read_b64_tr_b16 v[210:211], v21 offset:3072
    buffer_load_dwordx4 v[156:159], v11, s[24:27], s93 offen offset:1024 sc1
    v_mfma_f32_32x32x16_bf16 v[120:135], v[220:223], v[172:175], v[120:135]
    ds_read_b64_tr_b16 v[212:213], v22 offset:2048
    v_mfma_f32_32x32x16_bf16 v[104:119], v[220:223], v[168:171], v[104:119]
    ds_read_b64_tr_b16 v[214:215], v22 offset:3072
    s_waitcnt vmcnt(12) lgkmcnt(4)
    v_mfma_f32_32x32x16_bf16 v[72:87], v[224:227], v[176:179], v[72:87]
    ds_read_b64_tr_b16 v[216:217], v21 offset:4096
    buffer_load_dwordx4 v[160:163], v10, s[24:27], s93 offen offset:2048 sc1
    v_mfma_f32_32x32x16_bf16 v[88:103], v[224:227], v[180:183], v[88:103]
    ds_read_b64_tr_b16 v[218:219], v21 offset:5120
    buffer_load_dwordx4 v[164:167], v11, s[24:27], s93 offen offset:2048 sc1
    v_mfma_f32_32x32x16_bf16 v[120:135], v[228:231], v[180:183], v[120:135]
    ds_read_b64_tr_b16 v[220:221], v22 offset:4096
    v_mfma_f32_32x32x16_bf16 v[104:119], v[228:231], v[176:179], v[104:119]
    ds_read_b64_tr_b16 v[222:223], v22 offset:5120
    s_waitcnt vmcnt(12) lgkmcnt(4)
    v_mfma_f32_32x32x16_bf16 v[72:87], v[232:235], v[184:187], v[72:87]
    ds_read_b64_tr_b16 v[224:225], v21 offset:6144
    buffer_load_dwordx4 v[168:171], v10, s[24:27], s93 offen offset:3072 sc1
    v_mfma_f32_32x32x16_bf16 v[88:103], v[232:235], v[188:191], v[88:103]
    ds_read_b64_tr_b16 v[226:227], v21 offset:7168
    buffer_load_dwordx4 v[172:175], v11, s[24:27], s93 offen offset:3072 sc1
    v_mfma_f32_32x32x16_bf16 v[120:135], v[236:239], v[188:191], v[120:135]
    ds_read_b64_tr_b16 v[228:229], v22 offset:6144
    v_mfma_f32_32x32x16_bf16 v[104:119], v[236:239], v[184:187], v[104:119]
    ds_read_b64_tr_b16 v[230:231], v22 offset:7168
    s_waitcnt vmcnt(12) lgkmcnt(4)
    v_mfma_f32_32x32x16_bf16 v[72:87], v[240:243], v[192:195], v[72:87]
    buffer_load_dwordx4 v[176:179], v10, s[24:27], s94 offen offset:0 sc1
    v_mfma_f32_32x32x16_bf16 v[88:103], v[240:243], v[196:199], v[88:103]
    buffer_load_dwordx4 v[180:183], v11, s[24:27], s94 offen offset:0 sc1
    v_mfma_f32_32x32x16_bf16 v[120:135], v[244:247], v[196:199], v[120:135]
    v_mfma_f32_32x32x16_bf16 v[104:119], v[244:247], v[192:195], v[104:119]
    s_waitcnt vmcnt(12) lgkmcnt(0)
    v_mfma_f32_32x32x16_bf16 v[72:87], v[248:251], v[64:67], v[72:87]
    buffer_load_dwordx4 v[184:187], v10, s[24:27], s94 offen offset:1024 sc1
    v_mfma_f32_32x32x16_bf16 v[88:103], v[248:251], v[68:71], v[88:103]
    buffer_load_dwordx4 v[232:235], v11, s[24:27], s94 offen offset:1024 sc1
    v_mfma_f32_32x32x16_bf16 v[120:135], v[252:255], v[68:71], v[120:135]
    v_mfma_f32_32x32x16_bf16 v[104:119], v[252:255], v[64:67], v[104:119]
    s_waitcnt vmcnt(12)
    v_mfma_f32_32x32x16_bf16 v[72:87], v[24:27], v[136:139], v[72:87]
    buffer_load_dwordx4 v[188:191], v10, s[24:27], s94 offen offset:2048 sc1
    v_mfma_f32_32x32x16_bf16 v[88:103], v[24:27], v[140:143], v[88:103]
    buffer_load_dwordx4 v[236:239], v11, s[24:27], s94 offen offset:2048 sc1
    v_mfma_f32_32x32x16_bf16 v[120:135], v[28:31], v[140:143], v[120:135]
    v_mfma_f32_32x32x16_bf16 v[104:119], v[28:31], v[136:139], v[104:119]
    buffer_load_dword v5, v12, s[48:51], 0 offen sc1
    s_waitcnt vmcnt(13)
    v_mfma_f32_32x32x16_bf16 v[72:87], v[32:35], v[144:147], v[72:87]
    buffer_load_dwordx4 v[192:195], v10, s[24:27], s94 offen offset:3072 sc1
    v_mfma_f32_32x32x16_bf16 v[88:103], v[32:35], v[148:151], v[88:103]
    v_mfma_f32_32x32x16_bf16 v[120:135], v[36:39], v[148:151], v[120:135]
    v_mfma_f32_32x32x16_bf16 v[104:119], v[36:39], v[144:147], v[104:119]
    s_waitcnt vmcnt(12)
    v_mfma_f32_32x32x16_bf16 v[72:87], v[40:43], v[152:155], v[72:87]
    buffer_load_dwordx4 v[240:243], v11, s[24:27], s94 offen offset:3072 sc1
    v_mfma_f32_32x32x16_bf16 v[88:103], v[40:43], v[156:159], v[88:103]
    v_mfma_f32_32x32x16_bf16 v[120:135], v[44:47], v[156:159], v[120:135]
    v_mfma_f32_32x32x16_bf16 v[104:119], v[44:47], v[152:155], v[104:119]
    s_waitcnt vmcnt(11)
    v_mfma_f32_32x32x16_bf16 v[72:87], v[48:51], v[160:163], v[72:87]
    v_mfma_f32_32x32x16_bf16 v[88:103], v[48:51], v[164:167], v[88:103]
    v_mfma_f32_32x32x16_bf16 v[120:135], v[52:55], v[164:167], v[120:135]
    v_mfma_f32_32x32x16_bf16 v[104:119], v[52:55], v[160:163], v[104:119]
    s_waitcnt vmcnt(9)
    v_mfma_f32_32x32x16_bf16 v[72:87], v[56:59], v[168:171], v[72:87]
    v_mfma_f32_32x32x16_bf16 v[88:103], v[56:59], v[172:175], v[88:103]
    v_mfma_f32_32x32x16_bf16 v[120:135], v[60:63], v[172:175], v[120:135]
    v_mfma_f32_32x32x16_bf16 v[104:119], v[60:63], v[168:171], v[104:119]
    s_waitcnt vmcnt(7)
    v_mfma_f32_32x32x16_bf16 v[88:103], v[200:203], v[180:183], v[88:103]
    s_waitcnt vmcnt(2)
    v_cmp_ne_u32 vcc, s62, v5
    s_cbranch_vccnz A_pa_slow
A_pa_ok:
    buffer_load_dwordx4 v[196:199], v13, s[12:15], s52 offen sc1
    buffer_load_dwordx4 v[244:247], v13, s[12:15], s53 offen sc1
    buffer_load_dword v18, v16, s[16:19], s54 offen sc1
    v_mfma_f32_32x32x16_bf16 v[88:103], v[208:211], v[232:235], v[88:103]
    v_mfma_f32_32x32x16_bf16 v[88:103], v[216:219], v[236:239], v[88:103]
    s_waitcnt vmcnt(3)
    v_mfma_f32_32x32x16_bf16 v[88:103], v[224:227], v[240:243], v[88:103]
    v_mfma_f32_32x32x16_bf16 v[120:135], v[204:207], v[180:183], v[120:135]
    s_nop 4
    v_mfma_f32_32x32x16_bf16 v[120:135], v[212:215], v[232:235], v[120:135]
    s_nop 4
    ds_write_b128 v17, v[88:91] offset:0
    v_mfma_f32_32x32x16_bf16 v[120:135], v[220:223], v[236:239], v[120:135]
    ds_write_b128 v17, v[92:95] offset:1024
    v_mfma_f32_32x32x16_bf16 v[120:135], v[228:231], v[240:243], v[120:135]
    ds_write_b128 v17, v[96:99] offset:2048
    v_mfma_f32_32x32x16_bf16 v[104:119], v[204:207], v[176:179], v[104:119]
    s_nop 4
    v_mfma_f32_32x32x16_bf16 v[104:119], v[212:215], v[184:187], v[104:119]
    s_nop 4
    ds_write_b128 v17, v[100:103] offset:3072
    v_mfma_f32_32x32x16_bf16 v[104:119], v[220:223], v[188:191], v[104:119]
    ds_write_b128 v17, v[120:123] offset:8192
    v_mfma_f32_32x32x16_bf16 v[104:119], v[228:231], v[192:195], v[104:119]
    ds_write_b128 v17, v[124:127] offset:9216
    v_mfma_f32_32x32x16_bf16 v[72:87], v[200:203], v[176:179], v[72:87]
    s_nop 4
    v_mfma_f32_32x32x16_bf16 v[72:87], v[208:211], v[184:187], v[72:87]
    s_nop 4
    ds_write_b128 v17, v[128:131] offset:10240
    v_mfma_f32_32x32x16_bf16 v[72:87], v[216:219], v[188:191], v[72:87]
    ds_write_b128 v17, v[132:135] offset:11264
    v_mfma_f32_32x32x16_bf16 v[72:87], v[224:227], v[192:195], v[72:87]
    ds_write_b128 v17, v[104:107] offset:4096
    ds_write_b128 v17, v[108:111] offset:5120
    ds_write_b128 v17, v[112:115] offset:6144
    ds_write_b128 v17, v[116:119] offset:7168
    s_waitcnt vmcnt(0)
    ds_write_b128 v17, v[196:199] offset:12288
    ds_write_b128 v17, v[244:247] offset:13312
    ds_read_b64_tr_b16 v[196:197], v0 offset:12288
    ds_read_b64_tr_b16 v[198:199], v0 offset:12800
    ds_read_b64_tr_b16 v[244:245], v0 offset:13312
    ds_read_b64_tr_b16 v[246:247], v0 offset:13824
    v_sub_f32 v16, 1.0, v18
    v_cvt_pk_bf16_f32 v16, v16, v16
    v_and_b32 v16, 0xffff0000, v16
    s_waitcnt lgkmcnt(6)
    s_barrier
    ds_read_b128 v[40:43], v4 offset:0
    ds_read_b128 v[44:47], v4 offset:1024
    ds_read_b128 v[48:51], v4 offset:2048
    ds_read_b128 v[52:55], v4 offset:3072
    ds_read_b128 v[56:59], v19 offset:4096
    ds_read_b128 v[60:63], v19 offset:5120
    ds_read_b128 v[64:67], v19 offset:6144
    ds_read_b128 v[68:71], v19 offset:7168
    ds_read_b128 v[136:139], v23 offset:8192
    ds_read_b128 v[140:143], v23 offset:9216
    ds_read_b128 v[144:147], v23 offset:10240
    ds_read_b128 v[148:151], v23 offset:11264
    v_mov_b32 v17, v16
    v_mov_b32 v19, v18
    s_waitcnt lgkmcnt(12)
    v_lshlrev_b32 v24, 16, v196
    v_and_b32 v25, 0xffff0000, v196
    v_lshlrev_b32 v26, 16, v197
    v_and_b32 v27, 0xffff0000, v197
    v_lshlrev_b32 v28, 16, v198
    v_and_b32 v29, 0xffff0000, v198
    v_lshlrev_b32 v30, 16, v199
    v_and_b32 v31, 0xffff0000, v199
    v_lshlrev_b32 v32, 16, v244
    v_and_b32 v33, 0xffff0000, v244
    v_lshlrev_b32 v34, 16, v245
    v_and_b32 v35, 0xffff0000, v245
    v_lshlrev_b32 v36, 16, v246
    v_and_b32 v37, 0xffff0000, v246
    v_lshlrev_b32 v38, 16, v247
    v_and_b32 v39, 0xffff0000, v247
    v_pk_mul_f32 v[24:25], v[24:25], v[18:19]
    v_pk_mul_f32 v[26:27], v[26:27], v[18:19]
    v_pk_mul_f32 v[28:29], v[28:29], v[18:19]
    v_pk_mul_f32 v[30:31], v[30:31], v[18:19]
    v_pk_mul_f32 v[32:33], v[32:33], v[18:19]
    v_pk_mul_f32 v[34:35], v[34:35], v[18:19]
    v_pk_mul_f32 v[36:37], v[36:37], v[18:19]
    v_pk_mul_f32 v[38:39], v[38:39], v[18:19]
    s_waitcnt lgkmcnt(8)
    v_pk_add_f32 v[72:73], v[72:73], v[40:41]
    v_pk_add_f32 v[74:75], v[74:75], v[42:43]
    v_pk_add_f32 v[76:77], v[76:77], v[44:45]
    v_pk_add_f32 v[78:79], v[78:79], v[46:47]
    v_pk_add_f32 v[80:81], v[80:81], v[48:49]
    v_pk_add_f32 v[82:83], v[82:83], v[50:51]
    v_pk_add_f32 v[84:85], v[84:85], v[52:53]
    v_pk_add_f32 v[86:87], v[86:87], v[54:55]
    s_waitcnt lgkmcnt(4)
    v_pk_add_f32 v[72:73], v[72:73], v[56:57]
    v_pk_add_f32 v[74:75], v[74:75], v[58:59]
    v_pk_add_f32 v[76:77], v[76:77], v[60:61]
    v_pk_add_f32 v[78:79], v[78:79], v[62:63]
    v_pk_add_f32 v[80:81], v[80:81], v[64:65]
    v_pk_add_f32 v[82:83], v[82:83], v[66:67]
    v_pk_add_f32 v[84:85], v[84:85], v[68:69]
    v_pk_add_f32 v[86:87], v[86:87], v[70:71]
    s_waitcnt lgkmcnt(0)
    v_pk_add_f32 v[72:73], v[72:73], v[136:137]
    v_pk_add_f32 v[74:75], v[74:75], v[138:139]
    v_pk_add_f32 v[76:77], v[76:77], v[140:141]
    v_pk_add_f32 v[78:79], v[78:79], v[142:143]
    v_pk_add_f32 v[80:81], v[80:81], v[144:145]
    v_pk_add_f32 v[82:83], v[82:83], v[146:147]
    v_pk_add_f32 v[84:85], v[84:85], v[148:149]
    v_pk_add_f32 v[86:87], v[86:87], v[150:151]
    v_pk_fma_f32 v[72:73], v[72:73], v[16:17], v[24:25]
    v_pk_fma_f32 v[74:75], v[74:75], v[16:17], v[26:27]
    v_pk_fma_f32 v[76:77], v[76:77], v[16:17], v[28:29]
    v_pk_fma_f32 v[78:79], v[78:79], v[16:17], v[30:31]
    v_pk_fma_f32 v[80:81], v[80:81], v[16:17], v[32:33]
    v_pk_fma_f32 v[82:83], v[82:83], v[16:17], v[34:35]
    v_pk_fma_f32 v[84:85], v[84:85], v[16:17], v[36:37]
    v_pk_fma_f32 v[86:87], v[86:87], v[16:17], v[38:39]
    v_cvt_pk_bf16_f32 v88, v72, v73
    v_cvt_pk_bf16_f32 v89, v74, v75
    v_cvt_pk_bf16_f32 v90, v76, v77
    v_cvt_pk_bf16_f32 v91, v78, v79
    v_cvt_pk_bf16_f32 v92, v80, v81
    v_cvt_pk_bf16_f32 v93, v82, v83
    v_cvt_pk_bf16_f32 v94, v84, v85
    v_cvt_pk_bf16_f32 v95, v86, v87
    s_nop 1
    v_permlane32_swap_b32 v88, v90
    v_permlane32_swap_b32 v89, v91
    v_permlane32_swap_b32 v92, v94
    v_permlane32_swap_b32 v93, v95
    buffer_store_dwordx4 v[88:91], v1, s[20:23], s55 offen offset:0
    buffer_store_dwordx4 v[92:95], v1, s[20:23], s55 offen offset:32
    s_endpgm
K_B:
    global_load_dword v16, v40, s[72:73]
    global_load_dword v17, v40, s[74:75]
    global_load_ushort v15, v41, s[84:85]
    global_load_ushort v23, v41, s[86:87]
    v_mov_b32 v251, v40
    s_lshr_b32 s34, s2, 1
    s_mul_i32 s34, s34, 2
    s_add_u32 s34, s34, s28
    s_bitcmp1_b32 s34, 0
    s_cselect_b32 s44, s10, s8
    s_cselect_b32 s45, s11, s9
    s_lshr_b32 s34, s34, 1
    s_mul_i32 s34, s34, 3584
    s_and_b32 s43, s2, 1
    s_mul_i32 s35, s43, 1792
    s_add_u32 s34, s34, s35
    s_add_u32 s34, s34, 57344
    s_lshl_b32 s35, s31, 1
    s_add_u32 s35, s35, s43
    s_mul_i32 s35, s35, 10
    s_min_u32 s35, s35, 502
    s_and_b32 s42, s2, 6
    s_lshl_b32 s42, s42, 8
    s_add_u32 s35, s35, s42
    s_mul_i32 s35, s35, 896
    s_add_u32 s35, s35, 128
    s_cmp_lt_u32 s28, 2
    s_cselect_b32 s46, 1605632, 0
    s_cmp_eq_u32 s28, 3
    s_cselect_b32 s44, s4, s44
    s_cselect_b32 s45, s5, s45
    s_cselect_b32 s34, s35, s34
    s_cselect_b32 s46, 1835008, s46
    s_mov_b32 s47, 0x20000
    s_cselect_b32 s42, 9, 13
    s_cselect_b32 s43, 768, 0
    v_min_u32 v4, s42, v2
    v_lshrrev_b32 v5, 0, v4
    v_mul_u32_u24 v5, s43, v5
    v_lshl_add_u32 v4, v4, 7, v5
    buffer_load_dword v252, v4, s[44:47], s34 offen
    s_mov_b32 s30, s3
    s_mov_b32 s57, s61
    s_mul_i32 s34, s61, 401408
    s_lshl_b32 s35, s40, 13
    s_add_u32 s34, s34, s35
    s_lshl_b32 s35, s28, 11
    s_add_u32 s31, s34, s35
    s_mov_b32 s8, s54
    s_mov_b32 s9, s55
    s_mov_b32 s10, 1605632
    s_mov_b32 s11, 0x20000
    s_lshr_b32 s4, s33, 1
    s_and_b32 s34, s33, 1
    s_lshl_b32 s35, s32, 1
    s_add_u32 s35, s35, s34
    s_lshl_b32 s5, s4, 2
    s_add_u32 s5, s5, s28
    s_lshl_b32 s55, s5, 5
    s_add_u32 s55, s55, s35
    s_lshl_b32 s55, s55, 7
    s_add_u32 s55, s55, 233472
    s_mul_i32 s35, s35, 57344
    s_lshl_b32 s5, s5, 10
    s_add_u32 s5, s5, s35
    s_add_u32 s5, s5, 8945664
    s_add_u32 s54, s5, 28672
    v_lshrrev_b32 v5, 3, v2
    v_lshl_add_u32 v5, v1, 4, v5
    v_mul_u32_u24 v5, 896, v5
    v_and_b32 v6, 7, v2
    v_lshl_add_u32 v49, v6, 4, v5
    s_mul_i32 s34, s34, 57344
    s_lshl_b32 s4, s4, 7
    s_add_u32 s4, s4, s34
    v_lshrrev_b32 v4, 4, v2
    v_bfe_u32 v5, v2, 2, 2
    v_lshl_add_u32 v6, v4, 3, v5
    v_lshlrev_b32 v6, 7, v6
    v_and_b32 v5, 3, v2
    v_lshl_add_u32 v6, v5, 3, v6
    v_lshl_add_u32 v6, v1, 5, v6
    v_add_u32 v48, 150016, v6
    v_and_b32 v5, 15, v2
    v_lshlrev_b32 v5, 6, v5
    v_lshl_add_u32 v52, v4, 4, v5
    v_lshlrev_b32 v3, 4, v2
    s_mov_b32 s24, s6
    s_mov_b32 s25, s7
    s_mov_b32 s26, 21127168
    s_mov_b32 s27, 0x20000
    s_add_u32 s48, s6, 12615680
    s_addc_u32 s49, s7, 0
    s_mov_b32 s50, 348160
    s_mov_b32 s51, 0x20000
    v_mov_b32 v22, 0
    s_lshl_b32 s34, s28, 2
    s_add_u32 s34, s34, 159248
    v_mov_b32 v249, s34
    s_xor_b32 s34, s34, 4
    v_mov_b32 v250, s34
    ds_write_b32 v249, v22
    v_subrev_u32 v6, 16, v249
    ds_write_b32 v6, v22
    s_mul_i32 s41, s36, 4608
    s_add_u32 s41, s41, 150016
    s_mul_i32 s40, s36, 17664
    s_add_u32 s40, s40, 65536
    s_mul_i32 s29, s28, 8832
    s_add_u32 s32, s29, 32768
    s_add_u32 s29, s29, 65536
    v_and_b32 v6, 31, v2
    v_mul_u32_u24 v13, 272, v6
    v_lshrrev_b32 v7, 5, v2
    v_lshl_add_u32 v13, v7, 4, v13
    v_add_u32 v13, s29, v13
    v_and_b32 v14, 31, v2
    v_lshlrev_b32 v14, 7, v14
    s_lshr_b32 s34, s30, 4
    s_lshl_b32 s34, s34, 12
    s_add_u32 s34, s34, 233472
    v_add_u32 v14, s34, v14
    v_lshrrev_b32 v6, 2, v2
    v_mul_u32_u24 v6, 28672, v6
    v_and_b32 v7, 3, v2
    v_lshl_add_u32 v248, v7, 4, v6
    v_lshlrev_b32 v86, 3, v2
    s_lshl_b32 s34, s37, 9
    v_add_u32 v86, s34, v86
    s_lshl_b32 s44, s36, 13
    s_add_u32 s47, s44, 117248
    s_sub_u32 s46, s47, 68096
    s_add_u32 s45, s47, 512
    v_cvt_f32_u32 v87, v86
    v_lshlrev_b32 v86, 2, v86
    v_sub_u32 v86, s47, v86
    v_sub_f32 v84, 0x44ffe000, v87
    v_sub_f32 v85, 0x44ffc000, v87
    v_cvt_pk_bf16_f32 v84, v84, v85
    v_mad_u32_u16 v100, v84, 4, s46 op_sel:[0,0,0,0]
    v_mad_u32_u16 v101, v84, 4, s46 op_sel:[1,0,0,0]
    v_sub_f32 v84, 0x44ffa000, v87
    v_sub_f32 v85, 0x44ff8000, v87
    v_cvt_pk_bf16_f32 v84, v84, v85
    v_mad_u32_u16 v102, v84, 4, s46 op_sel:[0,0,0,0]
    v_mad_u32_u16 v103, v84, 4, s46 op_sel:[1,0,0,0]
    v_sub_f32 v84, 0x44ff6000, v87
    v_sub_f32 v85, 0x44ff4000, v87
    v_cvt_pk_bf16_f32 v84, v84, v85
    v_mad_u32_u16 v104, v84, 4, s46 op_sel:[0,0,0,0]
    v_mad_u32_u16 v105, v84, 4, s46 op_sel:[1,0,0,0]
    v_sub_f32 v84, 0x44ff2000, v87
    v_sub_f32 v85, 0x44ff0000, v87
    v_cvt_pk_bf16_f32 v84, v84, v85
    v_mad_u32_u16 v106, v84, 4, s46 op_sel:[0,0,0,0]
    v_mad_u32_u16 v107, v84, 4, s46 op_sel:[1,0,0,0]
    v_sub_f32 v84, 0x447fc000, v87
    v_sub_f32 v85, 0x447f8000, v87
    v_cvt_pk_bf16_f32 v84, v84, v85
    v_mad_u32_u16 v108, v84, 4, s46 op_sel:[0,0,0,0]
    v_add_u32 v85, 4092, v86
    v_med3_i32 v108, v108, v85, s45
    v_mad_u32_u16 v109, v84, 4, s46 op_sel:[1,0,0,0]
    v_add_u32 v85, 4088, v86
    v_med3_i32 v109, v109, v85, s45
    v_sub_f32 v84, 0x447f4000, v87
    v_sub_f32 v85, 0x447f0000, v87
    v_cvt_pk_bf16_f32 v84, v84, v85
    v_mad_u32_u16 v110, v84, 4, s46 op_sel:[0,0,0,0]
    v_add_u32 v85, 4084, v86
    v_med3_i32 v110, v110, v85, s45
    v_mad_u32_u16 v111, v84, 4, s46 op_sel:[1,0,0,0]
    v_add_u32 v85, 4080, v86
    v_med3_i32 v111, v111, v85, s45
    v_sub_f32 v84, 0x447ec000, v87
    v_sub_f32 v85, 0x447e8000, v87
    v_cvt_pk_bf16_f32 v84, v84, v85
    v_mad_u32_u16 v112, v84, 4, s46 op_sel:[0,0,0,0]
    v_add_u32 v85, 4076, v86
    v_med3_i32 v112, v112, v85, s45
    v_mad_u32_u16 v113, v84, 4, s46 op_sel:[1,0,0,0]
    v_add_u32 v85, 4072, v86
    v_med3_i32 v113, v113, v85, s45
    v_sub_f32 v84, 0x447e4000, v87
    v_sub_f32 v85, 0x447e0000, v87
    v_cvt_pk_bf16_f32 v84, v84, v85
    v_mad_u32_u16 v114, v84, 4, s46 op_sel:[0,0,0,0]
    v_add_u32 v85, 4068, v86
    v_med3_i32 v114, v114, v85, s45
    v_mad_u32_u16 v115, v84, 4, s46 op_sel:[1,0,0,0]
    v_add_u32 v85, 4064, v86
    v_med3_i32 v115, v115, v85, s45
    s_lshl_b32 s33, s28, 12
    s_add_u32 s33, s33, 117248
    s_mov_b32 s34, s33
    v_and_b32 v241, 31, v2
    v_lshrrev_b32 v242, 5, v2
    v_lshlrev_b32 v236, 5, v241
    v_lshl_add_u32 v236, v242, 4, v236
    v_add_u32 v236, s34, v236
    v_cmp_eq_u32 s[52:53], 1, v242
    v_lshlrev_b32 v237, 4, v241
    v_add_u32 v237, 1024, v237
    v_lshlrev_b32 v238, 3, v241
    v_add_u32 v238, 1536, v238
    v_add_u32 v239, 8, v237
    v_add_u32 v240, 256, v238
    v_cndmask_b32 v237, v237, v238, s[52:53]
    v_cndmask_b32 v238, v239, v240, s[52:53]
    v_add_u32 v237, s34, v237
    v_add_u32 v238, s34, v238
    v_lshlrev_b32 v239, 2, v241
    v_lshl_add_u32 v239, v242, 9, v239
    v_add_u32 v239, s34, v239
    s_lshl_b32 s34, s37, 10
    s_add_u32 s34, s34, s41
    v_add_u32 v241, s34, v3
    v_and_b32 v245, 15, v2
    v_lshrrev_b32 v246, 4, v2
    v_lshlrev_b32 v244, 4, v245
    v_add_u32 v244, s41, v244
    v_add_u32 v98, s29, v3
    v_and_b32 v240, 31, v2
    v_min_u32 v240, 16, v240
    v_lshlrev_b32 v240, 4, v240
    v_lshrrev_b32 v247, 5, v2
    v_mul_u32_u24 v247, 4416, v247
    v_add_u32 v240, v240, v247
    v_add_u32 v240, s29, v240
    v_sub_u32 v247, v246, v245
    v_lshlrev_b32 v247, 4, v247
    s_lshl_b32 s45, s37, 8
    s_sub_u32 s46, s41, s45
    s_add_u32 s47, s46, 496
    v_add_u32 v242, s47, v247
    v_sub_u32 v247, 3, v245
    v_and_b32 v247, 3, v247
    v_mul_u32_u24 v247, 4416, v247
    v_lshl_add_u32 v247, v246, 4, v247
    v_bfe_u32 v97, v2, 2, 1
    v_lshl_add_u32 v247, v97, 3, v247
    v_bfe_u32 v97, v2, 3, 1
    v_lshl_add_u32 v247, v97, 8, v247
    s_sub_u32 s46, s40, s45
    s_add_u32 s47, s46, 264
    v_add_u32 v243, s47, v247
    v_lshlrev_b32 v247, 4, v245
    v_bfe_u32 v97, v2, 5, 1
    v_lshl_add_u32 v247, v97, 8, v247
    v_bfe_u32 v97, v2, 4, 1
    v_lshl_add_u32 v247, v97, 9, v247
    s_lshl_b32 s45, s37, 11
    v_add_u32 v245, s33, v3
    s_xor_b32 s34, s28, 1
    s_lshl_b32 s34, s34, 12
    s_add_u32 s34, s34, 117248
    v_add_u32 v246, s34, v3
    s_lshl_b32 s46, s30, 12
    s_add_u32 s46, s46, s45
    s_add_u32 s46, s46, 10780672
    s_mul_i32 s34, s37, 448
    s_add_u32 s34, s34, s30
    s_lshl_b32 s34, s34, 7
    s_add_u32 s61, s34, 118784
    s_waitcnt lgkmcnt(0)
    s_barrier
    s_add_u32 m0, s39, 16384
    s_mov_b32 s35, 114688
    buffer_load_dwordx4 v12, s[16:19], s35 offen offset:0 lds
    buffer_load_dwordx4 v12, s[20:23], s35 offen offset:1024 lds
    s_add_u32 m0, s38, 16384
    s_movk_i32 s35, 128
    buffer_load_dwordx4 v8, s[12:15], s35 offen offset:0 lds
    buffer_load_dwordx4 v9, s[12:15], s35 offen offset:1024 lds
    s_barrier
    s_add_u32 m0, s38, 16384
    s_movk_i32 s35, 128
    buffer_load_dwordx4 v10, s[12:15], s35 offen offset:2048 lds
    buffer_load_dwordx4 v11, s[12:15], s35 offen offset:3072 lds
    s_add_u32 m0, s39, 24576
    s_mov_b32 s35, 172032
    buffer_load_dwordx4 v12, s[16:19], s35 offen offset:0 lds
    buffer_load_dwordx4 v12, s[20:23], s35 offen offset:1024 lds
    s_add_u32 m0, s39, 32768
    s_mov_b32 s35, 229376
    buffer_load_dwordx4 v12, s[16:19], s35 offen offset:0 lds
    buffer_load_dwordx4 v12, s[20:23], s35 offen offset:1024 lds
    s_waitcnt vmcnt(11)
    v_lshlrev_b32 v6, 16, v15
    v_lshlrev_b32 v23, 16, v23
    v_mul_f32 v7, 0x3fb8aa00, v6
    v_readfirstlane_b32 s60, v23
    v_rndne_f32 v4, v7
    v_sub_f32 v7, v7, v4
    v_mov_b32 v5, 0x36eca570
    v_fmac_f32 v7, v5, v6
    v_exp_f32 v7, v7
    v_cvt_i32_f32 v4, v4
    v_ldexp_f32 v7, v7, v4
    v_cvt_pk_bf16_f32 v7, v7, v7
    v_and_b32 v15, 0xffff0000, v7
    v_lshlrev_b32 v40, 16, v16
    v_lshlrev_b32 v41, 16, v17
    v_mul_f32 v40, v15, v40
    v_mul_f32 v41, v15, v41
    v_mul_f32 v40, 0x3fb8aa3b, v40
    v_mul_f32 v41, 0.15915494, v41
    v_mul_f32 v88, 0x41000000, v40
    v_mul_f32 v89, 0x41000000, v41
    v_fract_f32 v89, v89
    v_exp_f32 v88, v88
    v_sin_f32 v90, v89
    v_cos_f32 v89, v89
    s_nop 0
    v_mul_f32 v46, v88, v89
    v_mul_f32 v47, v88, v90
    v_mul_f32 v60, v46, v46
    v_mul_f32 v61, v47, v46
    v_fma_f32 v60, -v47, v47, v60
    v_fmac_f32 v61, v46, v47
    v_mov_b32 v124, 0x3f80
    v_cvt_pk_bf16_f32 v125, v46, v47
    v_mul_f32 v62, v60, v46
    v_mul_f32 v63, v61, v46
    v_fma_f32 v62, -v61, v47, v62
    v_fmac_f32 v63, v60, v47
    v_mul_f32 v54, v60, v60
    v_mul_f32 v55, v61, v60
    v_fma_f32 v54, -v61, v61, v54
    v_fmac_f32 v55, v60, v61
    v_sub_f32 v80, 0, v55
    v_cvt_pk_bf16_f32 v126, v60, v61
    v_cvt_pk_bf16_f32 v127, v62, v63
    s_waitcnt vmcnt(8)
    s_barrier
    s_add_u32 m0, s39, 40960
    s_mov_b32 s35, 286720
    buffer_load_dwordx4 v12, s[16:19], s35 offen offset:0 lds
    buffer_load_dwordx4 v12, s[20:23], s35 offen offset:1024 lds
    s_add_u32 m0, s39, 49152
    s_mov_b32 s35, 344064
    buffer_load_dwordx4 v12, s[16:19], s35 offen offset:0 lds
    buffer_load_dwordx4 v12, s[20:23], s35 offen offset:1024 lds
    s_add_u32 m0, s38, 32768
    s_movk_i32 s35, 256
    buffer_load_dwordx4 v8, s[12:15], s35 offen offset:0 lds
    buffer_load_dwordx4 v9, s[12:15], s35 offen offset:1024 lds
    v_mul_f32 v66, v46, v54
    v_mul_f32 v67, v47, v54
    v_fmac_f32 v66, v47, v80
    v_fmac_f32 v67, v46, v55
    v_mul_f32 v68, v60, v54
    v_mul_f32 v69, v61, v54
    v_fmac_f32 v68, v61, v80
    v_fmac_f32 v69, v60, v55
    v_cvt_pk_bf16_f32 v128, v54, v55
    v_cvt_pk_bf16_f32 v129, v66, v67
    v_mul_f32 v70, v62, v54
    v_mul_f32 v71, v63, v54
    v_fmac_f32 v70, v63, v80
    v_fmac_f32 v71, v62, v55
    v_mul_f32 v56, v54, v54
    v_mul_f32 v57, v55, v54
    v_fmac_f32 v56, v55, v80
    v_fmac_f32 v57, v54, v55
    v_cvt_pk_bf16_f32 v130, v68, v69
    v_cvt_pk_bf16_f32 v131, v70, v71
    v_mul_f32 v58, v66, v54
    v_mul_f32 v59, v67, v54
    v_fmac_f32 v58, v67, v80
    v_fmac_f32 v59, v66, v55
    v_mul_f32 v60, v68, v54
    v_mul_f32 v61, v69, v54
    v_fmac_f32 v60, v69, v80
    v_fmac_f32 v61, v68, v55
    v_cvt_pk_bf16_f32 v132, v56, v57
    v_cvt_pk_bf16_f32 v133, v58, v59
    v_mul_f32 v62, v70, v54
    v_mul_f32 v63, v71, v54
    v_fmac_f32 v62, v71, v80
    v_fmac_f32 v63, v70, v55
    v_mul_f32 v64, v56, v54
    v_mul_f32 v65, v57, v54
    v_fmac_f32 v64, v57, v80
    v_fmac_f32 v65, v56, v55
    v_cvt_pk_bf16_f32 v134, v60, v61
    v_cvt_pk_bf16_f32 v135, v62, v63
    v_mul_f32 v66, v58, v54
    v_mul_f32 v67, v59, v54
    v_fmac_f32 v66, v59, v80
    v_fmac_f32 v67, v58, v55
    v_mul_f32 v68, v60, v54
    s_waitcnt vmcnt(8)
    s_barrier
    s_add_u32 m0, s38, 32768
    s_movk_i32 s35, 256
    buffer_load_dwordx4 v10, s[12:15], s35 offen offset:2048 lds
    buffer_load_dwordx4 v11, s[12:15], s35 offen offset:3072 lds
    s_add_u32 m0, s39, 57344
    s_mov_b32 s35, 401408
    buffer_load_dwordx4 v12, s[16:19], s35 offen offset:0 lds
    buffer_load_dwordx4 v12, s[20:23], s35 offen offset:1024 lds
    s_add_u32 m0, s39, 0
    s_mov_b32 s35, 458752
    buffer_load_dwordx4 v12, s[16:19], s35 offen offset:0 lds
    buffer_load_dwordx4 v12, s[20:23], s35 offen offset:1024 lds
    v_mul_f32 v69, v61, v54
    v_fmac_f32 v68, v61, v80
    v_fmac_f32 v69, v60, v55
    v_cvt_pk_bf16_f32 v136, v64, v65
    v_cvt_pk_bf16_f32 v137, v66, v67
    v_mul_f32 v70, v62, v54
    v_mul_f32 v71, v63, v54
    v_fmac_f32 v70, v63, v80
    v_fmac_f32 v71, v62, v55
    v_mul_f32 v56, v64, v54
    v_mul_f32 v57, v65, v54
    v_fmac_f32 v56, v65, v80
    v_fmac_f32 v57, v64, v55
    v_cvt_pk_bf16_f32 v138, v68, v69
    v_cvt_pk_bf16_f32 v139, v70, v71
    v_mul_f32 v58, v66, v54
    v_mul_f32 v59, v67, v54
    v_fmac_f32 v58, v67, v80
    v_fmac_f32 v59, v66, v55
    v_mul_f32 v60, v68, v54
    v_mul_f32 v61, v69, v54
    v_fmac_f32 v60, v69, v80
    v_fmac_f32 v61, v68, v55
    v_cvt_pk_bf16_f32 v140, v56, v57
    v_cvt_pk_bf16_f32 v141, v58, v59
    v_mul_f32 v62, v70, v54
    v_mul_f32 v63, v71, v54
    v_fmac_f32 v62, v71, v80
    v_fmac_f32 v63, v70, v55
    v_mul_f32 v64, v56, v54
    v_mul_f32 v65, v57, v54
    v_fmac_f32 v64, v57, v80
    v_fmac_f32 v65, v56, v55
    v_cvt_pk_bf16_f32 v142, v60, v61
    v_cvt_pk_bf16_f32 v143, v62, v63
    v_mul_f32 v66, v58, v54
    v_mul_f32 v67, v59, v54
    v_fmac_f32 v66, v59, v80
    v_fmac_f32 v67, v58, v55
    v_mul_f32 v68, v60, v54
    v_mul_f32 v69, v61, v54
    v_fmac_f32 v68, v61, v80
    v_fmac_f32 v69, v60, v55
    v_cvt_pk_bf16_f32 v144, v64, v65
    v_cvt_pk_bf16_f32 v145, v66, v67
    s_waitcnt vmcnt(12)
    s_barrier
    s_add_u32 m0, s39, 8192
    s_mov_b32 s35, 516096
    buffer_load_dwordx4 v12, s[16:19], s35 offen offset:0 lds
    buffer_load_dwordx4 v12, s[20:23], s35 offen offset:1024 lds
    s_add_u32 m0, s39, 16384
    s_mov_b32 s35, 573440
    buffer_load_dwordx4 v12, s[16:19], s35 offen offset:0 lds
    buffer_load_dwordx4 v12, s[20:23], s35 offen offset:1024 lds
    s_add_u32 m0, s38, 0
    s_movk_i32 s35, 384
    buffer_load_dwordx4 v8, s[12:15], s35 offen offset:0 lds
    buffer_load_dwordx4 v9, s[12:15], s35 offen offset:1024 lds
    v_mul_f32 v70, v62, v54
    v_mul_f32 v71, v63, v54
    v_fmac_f32 v70, v63, v80
    v_fmac_f32 v71, v62, v55
    v_mul_f32 v56, v64, v54
    v_mul_f32 v57, v65, v54
    v_fmac_f32 v56, v65, v80
    v_fmac_f32 v57, v64, v55
    v_cvt_pk_bf16_f32 v146, v68, v69
    v_cvt_pk_bf16_f32 v147, v70, v71
    v_mul_f32 v58, v66, v54
    v_mul_f32 v59, v67, v54
    v_fmac_f32 v58, v67, v80
    v_fmac_f32 v59, v66, v55
    v_mul_f32 v60, v68, v54
    v_mul_f32 v61, v69, v54
    v_fmac_f32 v60, v69, v80
    v_fmac_f32 v61, v68, v55
    v_cvt_pk_bf16_f32 v148, v56, v57
    v_cvt_pk_bf16_f32 v149, v58, v59
    v_mul_f32 v62, v70, v54
    v_mul_f32 v63, v71, v54
    v_fmac_f32 v62, v71, v80
    v_fmac_f32 v63, v70, v55
    v_mul_f32 v64, v56, v54
    v_mul_f32 v65, v57, v54
    v_fmac_f32 v64, v57, v80
    v_fmac_f32 v65, v56, v55
    v_cvt_pk_bf16_f32 v150, v60, v61
    v_cvt_pk_bf16_f32 v151, v62, v63
    v_mul_f32 v66, v58, v54
    v_mul_f32 v67, v59, v54
    v_fmac_f32 v66, v59, v80
    v_fmac_f32 v67, v58, v55
    v_mul_f32 v68, v60, v54
    v_mul_f32 v69, v61, v54
    v_fmac_f32 v68, v61, v80
    v_fmac_f32 v69, v60, v55
    v_cvt_pk_bf16_f32 v152, v64, v65
    v_cvt_pk_bf16_f32 v153, v66, v67
    v_mul_f32 v70, v62, v54
    v_mul_f32 v71, v63, v54
    v_fmac_f32 v70, v63, v80
    v_fmac_f32 v71, v62, v55
    v_cvt_pk_bf16_f32 v154, v68, v69
    s_waitcnt vmcnt(16)
    s_barrier
    s_add_u32 m0, s38, 0
    s_movk_i32 s35, 384
    buffer_load_dwordx4 v10, s[12:15], s35 offen offset:2048 lds
    buffer_load_dwordx4 v11, s[12:15], s35 offen offset:3072 lds
    s_add_u32 m0, s39, 24576
    s_mov_b32 s35, 630784
    buffer_load_dwordx4 v12, s[16:19], s35 offen offset:0 lds
    buffer_load_dwordx4 v12, s[20:23], s35 offen offset:1024 lds
    v_cvt_pk_bf16_f32 v155, v70, v71
    v_and_b32 v53, 0xffff0000, v16
    v_and_b32 v83, 0xffff0000, v17
    v_mul_f32 v53, v15, v53
    v_mul_f32 v83, v15, v83
    v_mul_f32 v53, 0x3fb8aa3b, v53
    v_mul_f32 v83, 0.15915494, v83
    v_mul_f32 v88, 0x41000000, v53
    v_mul_f32 v89, 0x41000000, v83
    v_fract_f32 v89, v89
    v_exp_f32 v88, v88
    v_sin_f32 v90, v89
    v_cos_f32 v89, v89
    s_nop 0
    v_mul_f32 v46, v88, v89
    v_mul_f32 v47, v88, v90
    v_mul_f32 v60, v46, v46
    v_mul_f32 v61, v47, v46
    v_fma_f32 v60, -v47, v47, v60
    v_fmac_f32 v61, v46, v47
    v_mov_b32 v180, 0x3f80
    v_cvt_pk_bf16_f32 v181, v46, v47
    v_mul_f32 v62, v60, v46
    v_mul_f32 v63, v61, v46
    v_fma_f32 v62, -v61, v47, v62
    v_fmac_f32 v63, v60, v47
    v_mul_f32 v54, v60, v60
    v_mul_f32 v55, v61, v60
    v_fma_f32 v54, -v61, v61, v54
    v_fmac_f32 v55, v60, v61
    v_sub_f32 v80, 0, v55
    v_cvt_pk_bf16_f32 v182, v60, v61
    v_cvt_pk_bf16_f32 v183, v62, v63
    v_mul_f32 v66, v46, v54
    v_mul_f32 v67, v47, v54
    v_fmac_f32 v66, v47, v80
    v_fmac_f32 v67, v46, v55
    v_mul_f32 v68, v60, v54
    v_mul_f32 v69, v61, v54
    v_fmac_f32 v68, v61, v80
    v_fmac_f32 v69, v60, v55
    v_cvt_pk_bf16_f32 v184, v54, v55
    v_cvt_pk_bf16_f32 v185, v66, v67
    v_mul_f32 v70, v62, v54
    v_mul_f32 v71, v63, v54
    s_waitcnt vmcnt(18)
    s_barrier
    global_load_dword v18, v251, s[88:89]
    global_load_dword v19, v251, s[90:91]
    global_load_dword v20, v251, s[92:93]
    global_load_dword v21, v251, s[94:95]
    s_add_u32 m0, s39, 32768
    s_mov_b32 s35, 688128
    buffer_load_dwordx4 v12, s[16:19], s35 offen offset:0 lds
    buffer_load_dwordx4 v12, s[20:23], s35 offen offset:1024 lds
    s_add_u32 m0, s39, 40960
    s_mov_b32 s35, 745472
    buffer_load_dwordx4 v12, s[16:19], s35 offen offset:0 lds
    buffer_load_dwordx4 v12, s[20:23], s35 offen offset:1024 lds
    v_fmac_f32 v70, v63, v80
    v_fmac_f32 v71, v62, v55
    v_mul_f32 v56, v54, v54
    v_mul_f32 v57, v55, v54
    v_fmac_f32 v56, v55, v80
    v_fmac_f32 v57, v54, v55
    v_cvt_pk_bf16_f32 v186, v68, v69
    v_cvt_pk_bf16_f32 v187, v70, v71
    v_mul_f32 v58, v66, v54
    v_mul_f32 v59, v67, v54
    v_fmac_f32 v58, v67, v80
    v_fmac_f32 v59, v66, v55
    v_mul_f32 v60, v68, v54
    v_mul_f32 v61, v69, v54
    v_fmac_f32 v60, v69, v80
    v_fmac_f32 v61, v68, v55
    v_cvt_pk_bf16_f32 v188, v56, v57
    v_cvt_pk_bf16_f32 v189, v58, v59
    v_mul_f32 v62, v70, v54
    v_mul_f32 v63, v71, v54
    v_fmac_f32 v62, v71, v80
    v_fmac_f32 v63, v70, v55
    v_mul_f32 v64, v56, v54
    v_mul_f32 v65, v57, v54
    v_fmac_f32 v64, v57, v80
    v_fmac_f32 v65, v56, v55
    v_cvt_pk_bf16_f32 v190, v60, v61
    v_cvt_pk_bf16_f32 v191, v62, v63
    v_mul_f32 v66, v58, v54
    v_mul_f32 v67, v59, v54
    v_fmac_f32 v66, v59, v80
    v_fmac_f32 v67, v58, v55
    v_mul_f32 v68, v60, v54
    v_mul_f32 v69, v61, v54
    v_fmac_f32 v68, v61, v80
    v_fmac_f32 v69, v60, v55
    v_cvt_pk_bf16_f32 v192, v64, v65
    v_cvt_pk_bf16_f32 v193, v66, v67
    v_mul_f32 v70, v62, v54
    v_mul_f32 v71, v63, v54
    v_fmac_f32 v70, v63, v80
    v_fmac_f32 v71, v62, v55
    v_mul_f32 v56, v64, v54
    v_mul_f32 v57, v65, v54
    v_fmac_f32 v56, v65, v80
    s_waitcnt vmcnt(20)
    s_barrier
    s_add_u32 m0, s39, 49152
    s_mov_b32 s35, 802816
    buffer_load_dwordx4 v12, s[16:19], s35 offen offset:0 lds
    buffer_load_dwordx4 v12, s[20:23], s35 offen offset:1024 lds
    v_fmac_f32 v57, v64, v55
    v_cvt_pk_bf16_f32 v194, v68, v69
    v_cvt_pk_bf16_f32 v195, v70, v71
    v_mul_f32 v58, v66, v54
    v_mul_f32 v59, v67, v54
    v_fmac_f32 v58, v67, v80
    v_fmac_f32 v59, v66, v55
    v_mul_f32 v60, v68, v54
    v_mul_f32 v61, v69, v54
    v_fmac_f32 v60, v69, v80
    v_fmac_f32 v61, v68, v55
    v_cvt_pk_bf16_f32 v196, v56, v57
    v_cvt_pk_bf16_f32 v197, v58, v59
    v_mul_f32 v62, v70, v54
    v_mul_f32 v63, v71, v54
    v_fmac_f32 v62, v71, v80
    v_fmac_f32 v63, v70, v55
    v_mul_f32 v64, v56, v54
    v_mul_f32 v65, v57, v54
    v_fmac_f32 v64, v57, v80
    v_fmac_f32 v65, v56, v55
    v_cvt_pk_bf16_f32 v198, v60, v61
    v_cvt_pk_bf16_f32 v199, v62, v63
    v_mul_f32 v66, v58, v54
    v_mul_f32 v67, v59, v54
    v_fmac_f32 v66, v59, v80
    v_fmac_f32 v67, v58, v55
    v_mul_f32 v68, v60, v54
    v_mul_f32 v69, v61, v54
    v_fmac_f32 v68, v61, v80
    v_fmac_f32 v69, v60, v55
    v_cvt_pk_bf16_f32 v200, v64, v65
    v_cvt_pk_bf16_f32 v201, v66, v67
    v_mul_f32 v70, v62, v54
    v_mul_f32 v71, v63, v54
    v_fmac_f32 v70, v63, v80
    v_fmac_f32 v71, v62, v55
    v_mul_f32 v56, v64, v54
    v_mul_f32 v57, v65, v54
    v_fmac_f32 v56, v65, v80
    v_fmac_f32 v57, v64, v55
    v_cvt_pk_bf16_f32 v202, v68, v69
    v_cvt_pk_bf16_f32 v203, v70, v71
    v_mul_f32 v58, v66, v54
    v_mul_f32 v59, v67, v54
    s_waitcnt vmcnt(20)
    s_barrier
    s_add_u32 m0, s39, 150016
    s_add_u32 s35, s4, 6144
    buffer_load_dwordx4 v49, s[12:15], s4 offen lds
    buffer_load_dwordx4 v49, s[12:15], s35 offen offset:1024 lds
    s_waitcnt vmcnt(8)
    v_fmac_f32 v58, v67, v80
    v_fmac_f32 v59, v66, v55
    s_add_u32 m0, s38, 16384
    s_movk_i32 s35, 512
    buffer_load_dwordx4 v8, s[12:15], s35 offen offset:0 lds
    v_mul_f32 v60, v68, v54
    v_mul_f32 v61, v69, v54
    buffer_load_dwordx4 v9, s[12:15], s35 offen offset:1024 lds
    v_fmac_f32 v60, v69, v80
    v_fmac_f32 v61, v68, v55
    s_add_u32 m0, s38, 16384
    s_movk_i32 s35, 512
    buffer_load_dwordx4 v10, s[12:15], s35 offen offset:2048 lds
    v_cvt_pk_bf16_f32 v204, v56, v57
    v_cvt_pk_bf16_f32 v205, v58, v59
    buffer_load_dwordx4 v11, s[12:15], s35 offen offset:3072 lds
    v_mul_f32 v62, v70, v54
    v_mul_f32 v63, v71, v54
    s_barrier
    global_load_dword v122, v22, s[58:59] sc1
    v_fmac_f32 v62, v71, v80
    v_fmac_f32 v63, v70, v55
    v_mul_f32 v64, v56, v54
    s_add_u32 m0, s39, 57344
    s_mov_b32 s35, 860160
    buffer_load_dwordx4 v12, s[16:19], s35 offen offset:0 lds
    v_mul_f32 v65, v57, v54
    v_fmac_f32 v64, v57, v80
    v_fmac_f32 v65, v56, v55
    buffer_load_dwordx4 v12, s[20:23], s35 offen offset:1024 lds
    v_cvt_pk_bf16_f32 v206, v60, v61
    v_cvt_pk_bf16_f32 v207, v62, v63
    v_mul_f32 v66, v58, v54
    s_add_u32 m0, s39, 0
    s_mov_b32 s35, 917504
    buffer_load_dwordx4 v12, s[16:19], s35 offen offset:0 lds
    v_mul_f32 v67, v59, v54
    v_fmac_f32 v66, v59, v80
    v_fmac_f32 v67, v58, v55
    buffer_load_dwordx4 v12, s[20:23], s35 offen offset:1024 lds
    v_mul_f32 v68, v60, v54
    v_mul_f32 v69, v61, v54
    v_fmac_f32 v68, v61, v80
    v_fmac_f32 v69, v60, v55
    v_cvt_pk_bf16_f32 v208, v64, v65
    v_cvt_pk_bf16_f32 v209, v66, v67
    s_barrier
    v_mul_f32 v70, v62, v54
    v_mul_f32 v71, v63, v54
    v_fmac_f32 v70, v63, v80
    v_fmac_f32 v71, v62, v55
    v_cvt_pk_bf16_f32 v210, v68, v69
    v_cvt_pk_bf16_f32 v211, v70, v71
    v_mov_b32 v252, 0
    v_mov_b32 v253, 0
    s_add_u32 m0, s39, 8192
    s_mov_b32 s35, 974848
    buffer_load_dwordx4 v12, s[16:19], s35 offen offset:0 lds
    v_mov_b32 v254, 0
    v_mov_b32 v255, 0
    v_mul_f32 v88, 1.0, v40
    v_mul_f32 v89, 1.0, v41
    v_mul_f32 v91, 0x43800000, v40
    v_mul_f32 v92, 0x43800000, v41
    v_fract_f32 v89, v89
    v_fract_f32 v92, v92
    buffer_load_dwordx4 v12, s[20:23], s35 offen offset:1024 lds
    v_exp_f32 v88, v88
    v_sin_f32 v90, v89
    v_cos_f32 v89, v89
    v_exp_f32 v91, v91
    v_sin_f32 v93, v92
    v_cos_f32 v92, v92
    s_nop 0
    v_mul_f32 v44, v88, v89
    v_mul_f32 v45, v88, v90
    v_mul_f32 v50, v91, v92
    s_barrier
    v_mul_f32 v51, v91, v93
    v_lshlrev_b32 v88, 16, v18
    v_lshlrev_b32 v89, 16, v19
    v_lshlrev_b32 v90, 16, v20
    v_lshlrev_b32 v91, 16, v21
    v_mul_f32 v88, v15, v88
    v_mul_f32 v89, v15, v89
    v_sub_f32 v81, 0, v45
    s_add_u32 m0, s39, 16384
    s_mov_b32 s35, 1032192
    buffer_load_dwordx4 v12, s[16:19], s35 offen offset:0 lds
    v_sub_f32 v82, 0, v51
    v_mul_f32 v42, v90, v88
    v_mul_f32 v43, v91, v88
    v_fma_f32 v42, -v91, v89, v42
    v_fmac_f32 v43, v90, v89
    v_mul_f32 v72, v42, v50
    v_mul_f32 v73, v43, v50
    v_fmac_f32 v72, v43, v82
    buffer_load_dwordx4 v12, s[20:23], s35 offen offset:1024 lds
    v_fmac_f32 v73, v42, v51
    v_mul_f32 v58, v42, v44
    v_mul_f32 v59, v43, v44
    v_fmac_f32 v58, v43, v81
    v_fmac_f32 v59, v42, v45
    v_mul_f32 v60, v58, v44
    v_mul_f32 v61, v59, v44
    v_fmac_f32 v60, v59, v81
    v_fmac_f32 v61, v58, v45
    v_cvt_pk_bf16_f32 v156, v42, -v43
    s_waitcnt vmcnt(19)
    s_barrier
    v_cvt_pk_bf16_f32 v157, v58, -v59
    v_mul_f32 v62, v60, v44
    v_mul_f32 v63, v61, v44
    s_add_u32 m0, s38, 32768
    s_movk_i32 s35, 640
    buffer_load_dwordx4 v8, s[12:15], s35 offen offset:0 lds
    v_fmac_f32 v62, v61, v81
    v_fmac_f32 v63, v60, v45
    v_mul_f32 v64, v62, v44
    buffer_load_dwordx4 v9, s[12:15], s35 offen offset:1024 lds
    v_mul_f32 v65, v63, v44
    v_fmac_f32 v64, v63, v81
    v_fmac_f32 v65, v62, v45
    s_add_u32 m0, s38, 32768
    s_movk_i32 s35, 640
    buffer_load_dwordx4 v10, s[12:15], s35 offen offset:2048 lds
    v_cvt_pk_bf16_f32 v158, v60, -v61
    v_cvt_pk_bf16_f32 v159, v62, -v63
    v_mul_f32 v66, v64, v44
    buffer_load_dwordx4 v11, s[12:15], s35 offen offset:3072 lds
    v_mul_f32 v67, v65, v44
    v_fmac_f32 v66, v65, v81
    v_fmac_f32 v67, v64, v45
    v_mul_f32 v68, v66, v44
    v_mul_f32 v69, v67, v44
    v_fmac_f32 v68, v67, v81
    s_waitcnt vmcnt(21)
    s_barrier
    v_fmac_f32 v69, v66, v45
    v_cvt_pk_bf16_f32 v160, v64, -v65
    v_cvt_pk_bf16_f32 v161, v66, -v67
    s_add_u32 m0, s39, 24576
    s_mov_b32 s35, 1089536
    buffer_load_dwordx4 v12, s[16:19], s35 offen offset:0 lds
    v_mul_f32 v70, v68, v44
    v_mul_f32 v71, v69, v44
    v_fmac_f32 v70, v69, v81
    buffer_load_dwordx4 v12, s[20:23], s35 offen offset:1024 lds
    v_fmac_f32 v71, v68, v45
    v_mul_f32 v74, v60, v50
    v_mul_f32 v75, v61, v50
    s_add_u32 m0, s39, 32768
    s_mov_b32 s35, 1146880
    buffer_load_dwordx4 v12, s[16:19], s35 offen offset:0 lds
    v_fmac_f32 v74, v61, v82
    v_fmac_f32 v75, v60, v51
    v_cvt_pk_bf16_f32 v162, v68, -v69
    buffer_load_dwordx4 v12, s[20:23], s35 offen offset:1024 lds
    v_cvt_pk_bf16_f32 v163, v70, -v71
    v_mul_f32 v76, v64, v50
    v_mul_f32 v77, v65, v50
    v_fmac_f32 v76, v65, v82
    v_fmac_f32 v77, v64, v51
    v_cvt_pk_bf16_f32 v164, v72, -v73
    s_waitcnt vmcnt(21)
    s_barrier
    ds_read_b64_tr_b16 v[32:33], v48 offset:0
    ds_read_b64_tr_b16 v[34:35], v48 offset:512
    ds_read_b64_tr_b16 v[36:37], v48 offset:4096
    ds_read_b64_tr_b16 v[38:39], v48 offset:4608
    v_cvt_pk_bf16_f32 v165, v74, -v75
    v_mul_f32 v78, v68, v50
    v_mul_f32 v79, v69, v50
    v_fmac_f32 v78, v69, v82
    v_fmac_f32 v79, v68, v51
    v_mul_f32 v58, v72, v50
    v_mul_f32 v59, v73, v50
    v_fmac_f32 v58, v73, v82
    v_fmac_f32 v59, v72, v51
    v_cvt_pk_bf16_f32 v166, v76, -v77
    v_cvt_pk_bf16_f32 v167, v78, -v79
    v_mul_f32 v60, v76, v50
    v_mul_f32 v61, v77, v50
    v_fmac_f32 v60, v77, v82
    v_fmac_f32 v61, v76, v51
    v_mul_f32 v62, v58, v50
    s_waitcnt lgkmcnt(0)
    buffer_store_dwordx4 v[32:35], v52, s[24:27], s5 offen sc1
    buffer_store_dwordx4 v[36:39], v52, s[24:27], s54 offen sc1
    s_add_u32 m0, s39, 40960
    s_mov_b32 s35, 1204224
    buffer_load_dwordx4 v12, s[16:19], s35 offen offset:0 lds
    buffer_load_dwordx4 v12, s[20:23], s35 offen offset:1024 lds
    s_waitcnt vmcnt(18)
    s_barrier
    v_mul_f32 v63, v59, v50
    v_fmac_f32 v62, v59, v82
    v_fmac_f32 v63, v58, v51
    v_cvt_pk_bf16_f32 v168, v58, -v59
    v_cvt_pk_bf16_f32 v169, v60, -v61
    v_mul_f32 v64, v60, v50
    v_mul_f32 v65, v61, v50
    v_fmac_f32 v64, v61, v82
    s_add_u32 m0, s39, 49152
    s_mov_b32 s35, 1261568
    buffer_load_dwordx4 v12, s[16:19], s35 offen offset:0 lds
    v_fmac_f32 v65, v60, v51
    v_mul_f32 v66, v62, v50
    v_mul_f32 v67, v63, v50
    v_fmac_f32 v66, v63, v82
    v_fmac_f32 v67, v62, v51
    v_cvt_pk_bf16_f32 v170, v62, -v63
    v_cvt_pk_bf16_f32 v171, v64, -v65
    v_mul_f32 v68, v66, v50
    buffer_load_dwordx4 v12, s[20:23], s35 offen offset:1024 lds
    v_mul_f32 v69, v67, v50
    v_fmac_f32 v68, v67, v82
    v_fmac_f32 v69, v66, v51
    v_mul_f32 v70, v68, v50
    v_mul_f32 v71, v69, v50
    v_fmac_f32 v70, v69, v82
    v_fmac_f32 v71, v68, v51
    v_cvt_pk_bf16_f32 v172, v66, -v67
    v_cvt_pk_bf16_f32 v173, v68, -v69
    v_mul_f32 v72, v70, v50
    s_waitcnt vmcnt(18)
    s_barrier
    v_mul_f32 v73, v71, v50
    v_fmac_f32 v72, v71, v82
    v_fmac_f32 v73, v70, v51
    s_add_u32 m0, s38, 0
    s_movk_i32 s35, 768
    buffer_load_dwordx4 v8, s[12:15], s35 offen offset:0 lds
    v_mul_f32 v74, v72, v50
    v_mul_f32 v75, v73, v50
    v_fmac_f32 v74, v73, v82
    buffer_load_dwordx4 v9, s[12:15], s35 offen offset:1024 lds
    v_fmac_f32 v75, v72, v51
    v_cvt_pk_bf16_f32 v174, v70, -v71
    v_cvt_pk_bf16_f32 v175, v72, -v73
    s_add_u32 m0, s38, 0
    s_movk_i32 s35, 768
    buffer_load_dwordx4 v10, s[12:15], s35 offen offset:2048 lds
    v_cvt_pk_bf16_f32 v176, v74, -v75
    v_mul_f32 v88, 1.0, v53
    v_mul_f32 v89, 1.0, v83
    buffer_load_dwordx4 v11, s[12:15], s35 offen offset:3072 lds
    v_mul_f32 v91, 0x43800000, v53
    v_mul_f32 v92, 0x43800000, v83
    v_fract_f32 v89, v89
    v_fract_f32 v92, v92
    v_exp_f32 v88, v88
    v_sin_f32 v90, v89
    s_waitcnt vmcnt(20)
    s_barrier
    v_cos_f32 v89, v89
    v_exp_f32 v91, v91
    v_sin_f32 v93, v92
    s_add_u32 m0, s39, 57344
    s_mov_b32 s35, 1318912
    buffer_load_dwordx4 v12, s[16:19], s35 offen offset:0 lds
    v_cos_f32 v92, v92
    s_nop 0
    v_mul_f32 v44, v88, v89
    buffer_load_dwordx4 v12, s[20:23], s35 offen offset:1024 lds
    v_mul_f32 v45, v88, v90
    v_mul_f32 v50, v91, v92
    v_mul_f32 v51, v91, v93
    s_add_u32 m0, s39, 0
    s_mov_b32 s35, 1376256
    buffer_load_dwordx4 v12, s[16:19], s35 offen offset:0 lds
    v_and_b32 v88, 0xffff0000, v18
    v_and_b32 v89, 0xffff0000, v19
    v_and_b32 v90, 0xffff0000, v20
    buffer_load_dwordx4 v12, s[20:23], s35 offen offset:1024 lds
    v_and_b32 v91, 0xffff0000, v21
    v_mul_f32 v88, v15, v88
    v_mul_f32 v89, v15, v89
    v_sub_f32 v81, 0, v45
    v_sub_f32 v82, 0, v51
    v_mul_f32 v42, v90, v88
    s_waitcnt vmcnt(22)
    s_barrier
    v_mul_f32 v43, v91, v88
    v_fma_f32 v42, -v91, v89, v42
    v_fmac_f32 v43, v90, v89
    v_mul_f32 v72, v42, v50
    v_mul_f32 v73, v43, v50
    v_fmac_f32 v72, v43, v82
    v_fmac_f32 v73, v42, v51
    v_mul_f32 v58, v42, v44
    s_add_u32 m0, s39, 8192
    s_mov_b32 s35, 1433600
    buffer_load_dwordx4 v12, s[16:19], s35 offen offset:0 lds
    v_mul_f32 v59, v43, v44
    v_fmac_f32 v58, v43, v81
    v_fmac_f32 v59, v42, v45
    v_mul_f32 v60, v58, v44
    v_mul_f32 v61, v59, v44
    v_fmac_f32 v60, v59, v81
    v_fmac_f32 v61, v58, v45
    v_cvt_pk_bf16_f32 v212, v42, -v43
    buffer_load_dwordx4 v12, s[20:23], s35 offen offset:1024 lds
    v_cvt_pk_bf16_f32 v213, v58, -v59
    v_mul_f32 v62, v60, v44
    v_mul_f32 v63, v61, v44
    v_fmac_f32 v62, v61, v81
    v_fmac_f32 v63, v60, v45
    v_mul_f32 v64, v62, v44
    v_mul_f32 v65, v63, v44
    v_fmac_f32 v64, v63, v81
    v_fmac_f32 v65, v62, v45
    v_cvt_pk_bf16_f32 v214, v60, -v61
    s_waitcnt vmcnt(18)
    s_barrier
    v_readfirstlane_b32 s62, v122
    s_cmp_eq_u32 s62, 0
    s_cbranch_scc1 B_tag_slow
B_tag_ok:
    v_mov_b32 v23, s62
    s_waitcnt vmcnt(14)
    v_mov_b32 v32, s62
    v_mov_b32 v33, s62
    v_mov_b32 v34, s62
    v_mov_b32 v35, s62
    s_mov_b64 exec, 0xff
    buffer_store_dwordx4 v[32:35], v3, s[48:51], s55 offen sc1
    s_mov_b64 exec, -1
    v_cvt_pk_bf16_f32 v215, v62, -v63
    v_mul_f32 v66, v64, v44
    v_mul_f32 v67, v65, v44
    v_fmac_f32 v66, v65, v81
    v_fmac_f32 v67, v64, v45
    s_add_u32 m0, s39, 16384
    s_mov_b32 s35, 1490944
    buffer_load_dwordx4 v12, s[16:19], s35 offen offset:0 lds
    v_mul_f32 v68, v66, v44
    v_mul_f32 v69, v67, v44
    v_fmac_f32 v68, v67, v81
    v_fmac_f32 v69, v66, v45
    v_cvt_pk_bf16_f32 v216, v64, -v65
    buffer_load_dwordx4 v12, s[20:23], s35 offen offset:1024 lds
    v_cvt_pk_bf16_f32 v217, v66, -v67
    v_mul_f32 v70, v68, v44
    v_mul_f32 v71, v69, v44
    v_fmac_f32 v70, v69, v81
    v_fmac_f32 v71, v68, v45
    v_mul_f32 v74, v60, v50
    s_barrier
    v_mul_f32 v75, v61, v50
    v_fmac_f32 v74, v61, v82
    v_fmac_f32 v75, v60, v51
    v_cvt_pk_bf16_f32 v218, v68, -v69
    v_cvt_pk_bf16_f32 v219, v70, -v71
    v_mul_f32 v76, v64, v50
    v_mul_f32 v77, v65, v50
    v_fmac_f32 v76, v65, v82
    s_add_u32 m0, s39, 24576
    s_mov_b32 s35, 1548288
    buffer_load_dwordx4 v12, s[16:19], s35 offen offset:0 lds
    v_fmac_f32 v77, v64, v51
    v_cvt_pk_bf16_f32 v220, v72, -v73
    v_cvt_pk_bf16_f32 v221, v74, -v75
    v_mul_f32 v78, v68, v50
    v_mul_f32 v79, v69, v50
    v_fmac_f32 v78, v69, v82
    v_fmac_f32 v79, v68, v51
    v_mul_f32 v58, v72, v50
    buffer_load_dwordx4 v12, s[20:23], s35 offen offset:1024 lds
    v_mul_f32 v59, v73, v50
    v_fmac_f32 v58, v73, v82
    v_fmac_f32 v59, v72, v51
    v_cvt_pk_bf16_f32 v222, v76, -v77
    v_cvt_pk_bf16_f32 v223, v78, -v79
    v_mul_f32 v60, v76, v50
    v_mul_f32 v61, v77, v50
    v_fmac_f32 v60, v77, v82
    v_fmac_f32 v61, v76, v51
    v_mul_f32 v62, v58, v50
    s_waitcnt vmcnt(15)
    s_barrier
    s_mov_b32 m0, s32
    s_nop 0
    ds_write_addtid_b32 v124 offset:32768
    v_mul_f32 v63, v59, v50
    ds_write_addtid_b32 v125 offset:33040
    v_fmac_f32 v62, v59, v82
    ds_write_addtid_b32 v126 offset:33312
    v_fmac_f32 v63, v58, v51
    ds_write_addtid_b32 v127 offset:33584
    v_cvt_pk_bf16_f32 v224, v58, -v59
    ds_write_addtid_b32 v128 offset:33856
    v_cvt_pk_bf16_f32 v225, v60, -v61
    ds_write_addtid_b32 v129 offset:34128
    v_mul_f32 v64, v60, v50
    ds_write_addtid_b32 v130 offset:34400
    v_mul_f32 v65, v61, v50
    ds_write_addtid_b32 v131 offset:34672
    v_fmac_f32 v64, v61, v82
    v_fmac_f32 v65, v60, v51
    v_mul_f32 v66, v62, v50
    v_mul_f32 v67, v63, v50
    v_fmac_f32 v66, v63, v82
    v_fmac_f32 v67, v62, v51
    v_cvt_pk_bf16_f32 v226, v62, -v63
    v_cvt_pk_bf16_f32 v227, v64, -v65
    v_mul_f32 v68, v66, v50
    v_mul_f32 v69, v67, v50
    v_fmac_f32 v68, v67, v82
    v_fmac_f32 v69, v66, v51
    v_mul_f32 v70, v68, v50
    v_mul_f32 v71, v69, v50
    v_fmac_f32 v70, v69, v82
    v_fmac_f32 v71, v68, v51
    v_cvt_pk_bf16_f32 v228, v66, -v67
    v_cvt_pk_bf16_f32 v229, v68, -v69
    v_mul_f32 v72, v70, v50
    s_waitcnt vmcnt(7)
    s_barrier
    buffer_load_dword v123, v14, s[48:51], 0 offen sc1
    s_mov_b32 m0, s32
    s_nop 0
    ds_write_addtid_b32 v132 offset:34944
    v_mul_f32 v73, v71, v50
    ds_write_addtid_b32 v133 offset:35216
    v_fmac_f32 v72, v71, v82
    ds_write_addtid_b32 v134 offset:35488
    v_fmac_f32 v73, v70, v51
    ds_write_addtid_b32 v135 offset:35760
    v_mul_f32 v74, v72, v50
    ds_write_addtid_b32 v136 offset:36032
    v_mul_f32 v75, v73, v50
    ds_write_addtid_b32 v137 offset:36304
    v_fmac_f32 v74, v73, v82
    ds_write_addtid_b32 v138 offset:36576
    v_fmac_f32 v75, v72, v51
    ds_write_addtid_b32 v139 offset:36848
    v_cvt_pk_bf16_f32 v230, v70, -v71
    v_cvt_pk_bf16_f32 v231, v72, -v73
    v_cvt_pk_bf16_f32 v232, v74, -v75
    s_waitcnt vmcnt(1)
    s_barrier
    s_mov_b32 m0, s32
    s_nop 0
    ds_write_addtid_b32 v140 offset:37120
    ds_write_addtid_b32 v141 offset:37392
    ds_write_addtid_b32 v142 offset:37664
    ds_write_addtid_b32 v143 offset:37936
    ds_write_addtid_b32 v144 offset:38208
    ds_write_addtid_b32 v145 offset:38480
    ds_write_addtid_b32 v146 offset:38752
    ds_write_addtid_b32 v147 offset:39024
    ds_write_addtid_b32 v148 offset:39296
    ds_write_addtid_b32 v149 offset:39568
    ds_write_addtid_b32 v150 offset:39840
    ds_write_addtid_b32 v151 offset:40112
    ds_write_addtid_b32 v152 offset:40384
    ds_write_addtid_b32 v153 offset:40656
    ds_write_addtid_b32 v154 offset:40928
    ds_write_addtid_b32 v155 offset:41200
    ds_read_b128 v[124:127], v13 offset:0
    ds_read_b128 v[128:131], v13 offset:32
    ds_read_b128 v[132:135], v13 offset:64
    ds_read_b128 v[136:139], v13 offset:96
    ds_read_b128 v[140:143], v13 offset:128
    ds_read_b128 v[144:147], v13 offset:160
    ds_read_b128 v[148:151], v13 offset:192
    ds_read_b128 v[152:155], v13 offset:224
    ds_write_addtid_b32 v180 offset:32768
    ds_write_addtid_b32 v181 offset:33040
    ds_write_addtid_b32 v182 offset:33312
    ds_write_addtid_b32 v183 offset:33584
    ds_write_addtid_b32 v184 offset:33856
    s_waitcnt vmcnt(0)
    v_cmp_ne_u32 vcc, s62, v123
    s_cbranch_vccnz B_pu_slow
B_pu_ok:
    s_lshl_b32 s42, s30, 6
    s_add_u32 s42, s42, 8945664
    buffer_load_dwordx4 v[58:61], v248, s[24:27], s42 offen sc1
    s_add_u32 s42, s42, 458752
    buffer_load_dwordx4 v[64:67], v248, s[24:27], s42 offen sc1
    s_add_u32 s42, s42, 458752
    buffer_load_dwordx4 v[70:73], v248, s[24:27], s42 offen sc1
    s_add_u32 s42, s42, 458752
    buffer_load_dwordx4 v[76:79], v248, s[24:27], s42 offen sc1
    ds_write_addtid_b32 v185 offset:34128
    ds_write_addtid_b32 v186 offset:34400
    ds_write_addtid_b32 v187 offset:34672
    ds_write_addtid_b32 v188 offset:34944
    ds_write_addtid_b32 v189 offset:35216
    ds_write_addtid_b32 v190 offset:35488
    ds_write_addtid_b32 v191 offset:35760
    ds_write_addtid_b32 v192 offset:36032
    ds_write_addtid_b32 v193 offset:36304
    ds_write_addtid_b32 v194 offset:36576
    ds_write_addtid_b32 v195 offset:36848
    ds_write_addtid_b32 v196 offset:37120
    ds_write_addtid_b32 v197 offset:37392
    ds_write_addtid_b32 v198 offset:37664
    ds_write_addtid_b32 v199 offset:37936
    ds_write_addtid_b32 v200 offset:38208
    ds_write_addtid_b32 v201 offset:38480
    ds_write_addtid_b32 v202 offset:38752
    ds_write_addtid_b32 v203 offset:39024
    ds_write_addtid_b32 v204 offset:39296
    ds_write_addtid_b32 v205 offset:39568
    ds_write_addtid_b32 v206 offset:39840
    ds_write_addtid_b32 v207 offset:40112
    ds_write_addtid_b32 v208 offset:40384
    ds_write_addtid_b32 v209 offset:40656
    ds_write_addtid_b32 v210 offset:40928
    ds_write_addtid_b32 v211 offset:41200
    ds_read_b128 v[180:183], v13 offset:0
    ds_read_b128 v[184:187], v13 offset:32
    ds_read_b128 v[188:191], v13 offset:64
    ds_read_b128 v[192:195], v13 offset:96
    ds_read_b128 v[196:199], v13 offset:128
    ds_read_b128 v[200:203], v13 offset:160
    ds_read_b128 v[204:207], v13 offset:192
    ds_read_b128 v[208:211], v13 offset:224
    ds_write_addtid_b32 v156 offset:32768
    ds_write_addtid_b32 v157 offset:33040
    ds_write_addtid_b32 v158 offset:33312
    ds_write_addtid_b32 v159 offset:33584
    ds_write_addtid_b32 v160 offset:33856
    ds_write_addtid_b32 v161 offset:34128
    ds_write_addtid_b32 v162 offset:34400
    ds_write_addtid_b32 v163 offset:34672
    ds_write_addtid_b32 v164 offset:34944
    ds_write_addtid_b32 v165 offset:35216
    ds_write_addtid_b32 v166 offset:35488
    ds_write_addtid_b32 v167 offset:35760
    ds_write_addtid_b32 v168 offset:36032
    ds_write_addtid_b32 v169 offset:36304
    ds_write_addtid_b32 v170 offset:36576
    ds_write_addtid_b32 v171 offset:36848
    ds_write_addtid_b32 v172 offset:37120
    ds_write_addtid_b32 v173 offset:37392
    ds_write_addtid_b32 v174 offset:37664
    ds_write_addtid_b32 v175 offset:37936
    ds_write_addtid_b32 v176 offset:38208
    ds_read_b128 v[156:159], v13 offset:0
    ds_read_b128 v[160:163], v13 offset:32
    ds_read_b128 v[164:167], v13 offset:64
    ds_read_b128 v[168:171], v13 offset:96
    ds_read_b128 v[172:175], v13 offset:128
    ds_read_b128 v[176:179], v13 offset:160
    ds_read_b128 v[24:27], v13 offset:192
    ds_read_b128 v[28:31], v13 offset:224
    ds_write_addtid_b32 v212 offset:32768
    ds_write_addtid_b32 v213 offset:33040
    ds_write_addtid_b32 v214 offset:33312
    ds_write_addtid_b32 v215 offset:33584
    ds_write_addtid_b32 v216 offset:33856
    ds_write_addtid_b32 v217 offset:34128
    ds_write_addtid_b32 v218 offset:34400
    ds_write_addtid_b32 v219 offset:34672
    ds_write_addtid_b32 v220 offset:34944
    ds_write_addtid_b32 v221 offset:35216
    ds_write_addtid_b32 v222 offset:35488
    ds_write_addtid_b32 v223 offset:35760
    ds_write_addtid_b32 v224 offset:36032
    ds_write_addtid_b32 v225 offset:36304
    ds_write_addtid_b32 v226 offset:36576
    ds_write_addtid_b32 v227 offset:36848
    ds_write_addtid_b32 v228 offset:37120
    ds_write_addtid_b32 v229 offset:37392
    ds_write_addtid_b32 v230 offset:37664
    ds_write_addtid_b32 v231 offset:37936
    ds_write_addtid_b32 v232 offset:38208
    ds_read_b128 v[212:215], v13 offset:0
    ds_read_b128 v[216:219], v13 offset:32
    ds_read_b128 v[220:223], v13 offset:64
    ds_read_b128 v[224:227], v13 offset:96
    ds_read_b128 v[228:231], v13 offset:128
    ds_read_b128 v[232:235], v13 offset:160
    ds_read_b128 v[32:35], v13 offset:192
    ds_read_b128 v[36:39], v13 offset:224
    s_setprio 1
    s_waitcnt lgkmcnt(8)
    v_mfma_f32_32x32x16_bf16 v[40:55], v[156:159], v[124:127], 0
    s_cmp_eq_u32 s37, 0
    s_cselect_b32 s60, s60, 0
    ds_write_b128 v244, v[252:255] offset:4096
    ds_write_b128 v240, v[252:255]
    v_mfma_f32_32x32x16_bf16 v[40:55], v[160:163], v[128:131], v[40:55]
    s_waitcnt vmcnt(0)
    s_cmp_eq_u32 s37, 1
    s_cselect_b64 s[52:53], -1, 0
    v_mov_b32_dpp v56, v60 wave_shr:1 row_mask:0xf bank_mask:0xf bound_ctrl:0
    v_mov_b32_dpp v57, v61 wave_shr:1 row_mask:0xf bank_mask:0xf bound_ctrl:0
    v_cndmask_b32 v4, v58, v57, s[52:53]
    v_mfma_f32_32x32x16_bf16 v[40:55], v[164:167], v[132:135], v[40:55]
    v_cndmask_b32 v5, v59, v58, s[52:53]
    v_cndmask_b32 v6, v60, v59, s[52:53]
    v_cndmask_b32 v7, v61, v60, s[52:53]
    v_cndmask_b32 v96, v57, v56, s[52:53]
    v_alignbit_b32 v80, v4, v96, 16
    v_mfma_f32_32x32x16_bf16 v[40:55], v[168:171], v[136:139], v[40:55]
    v_alignbit_b32 v81, v5, v4, 16
    v_alignbit_b32 v82, v6, v5, 16
    v_alignbit_b32 v83, v7, v6, 16
    v_readlane_b32 s42, v60, 63
    v_readlane_b32 s43, v61, 63
    ds_write_b128 v98, v[4:7] offset:272
    v_mfma_f32_32x32x16_bf16 v[40:55], v[172:175], v[140:143], v[40:55]
    v_mov_b32_dpp v62, v66 wave_shr:1 row_mask:0xf bank_mask:0xf bound_ctrl:0
    v_mov_b32_dpp v63, v67 wave_shr:1 row_mask:0xf bank_mask:0xf bound_ctrl:0
    v_writelane_b32 v62, s42, 0
    v_writelane_b32 v63, s43, 0
    v_cndmask_b32 v8, v64, v63, s[52:53]
    ds_write_b128 v98, v[80:83] offset:4688
    v_mfma_f32_32x32x16_bf16 v[40:55], v[176:179], v[144:147], v[40:55]
    v_cndmask_b32 v9, v65, v64, s[52:53]
    v_cndmask_b32 v10, v66, v65, s[52:53]
    v_cndmask_b32 v11, v67, v66, s[52:53]
    v_cndmask_b32 v96, v63, v62, s[52:53]
    v_alignbit_b32 v84, v8, v96, 16
    v_mfma_f32_32x32x16_bf16 v[40:55], v[24:27], v[148:151], v[40:55]
    v_alignbit_b32 v85, v9, v8, 16
    v_alignbit_b32 v86, v10, v9, 16
    v_alignbit_b32 v87, v11, v10, 16
    v_readlane_b32 s42, v66, 63
    v_readlane_b32 s43, v67, 63
    ds_write_b128 v98, v[8:11] offset:1296
    v_mfma_f32_32x32x16_bf16 v[40:55], v[28:31], v[152:155], v[40:55]
    v_mov_b32_dpp v68, v72 wave_shr:1 row_mask:0xf bank_mask:0xf bound_ctrl:0
    v_mov_b32_dpp v69, v73 wave_shr:1 row_mask:0xf bank_mask:0xf bound_ctrl:0
    v_writelane_b32 v68, s42, 0
    v_writelane_b32 v69, s43, 0
    v_cndmask_b32 v16, v70, v69, s[52:53]
    ds_write_b128 v98, v[84:87] offset:5712
    s_waitcnt lgkmcnt(6)
    v_mfma_f32_32x32x16_bf16 v[40:55], v[212:215], v[180:183], v[40:55]
    v_cndmask_b32 v17, v71, v70, s[52:53]
    v_cndmask_b32 v18, v72, v71, s[52:53]
    v_cndmask_b32 v19, v73, v72, s[52:53]
    v_cndmask_b32 v96, v69, v68, s[52:53]
    v_alignbit_b32 v88, v16, v96, 16
    v_mfma_f32_32x32x16_bf16 v[40:55], v[216:219], v[184:187], v[40:55]
    v_alignbit_b32 v89, v17, v16, 16
    v_alignbit_b32 v90, v18, v17, 16
    v_alignbit_b32 v91, v19, v18, 16
    v_readlane_b32 s42, v72, 63
    v_readlane_b32 s43, v73, 63
    ds_write_b128 v98, v[16:19] offset:2320
    v_mfma_f32_32x32x16_bf16 v[40:55], v[220:223], v[188:191], v[40:55]
    v_mov_b32_dpp v74, v78 wave_shr:1 row_mask:0xf bank_mask:0xf bound_ctrl:0
    v_mov_b32_dpp v75, v79 wave_shr:1 row_mask:0xf bank_mask:0xf bound_ctrl:0
    v_writelane_b32 v74, s42, 0
    v_writelane_b32 v75, s43, 0
    v_cndmask_b32 v116, v76, v75, s[52:53]
    ds_write_b128 v98, v[88:91] offset:6736
    v_mfma_f32_32x32x16_bf16 v[40:55], v[224:227], v[192:195], v[40:55]
    v_cndmask_b32 v117, v77, v76, s[52:53]
    v_cndmask_b32 v118, v78, v77, s[52:53]
    v_cndmask_b32 v119, v79, v78, s[52:53]
    v_cndmask_b32 v96, v75, v74, s[52:53]
    v_alignbit_b32 v92, v116, v96, 16
    v_mfma_f32_32x32x16_bf16 v[40:55], v[228:231], v[196:199], v[40:55]
    v_alignbit_b32 v93, v117, v116, 16
    v_alignbit_b32 v94, v118, v117, 16
    v_alignbit_b32 v95, v119, v118, 16
    ds_write_b128 v98, v[116:119] offset:3344
    v_mfma_f32_32x32x16_bf16 v[40:55], v[232:235], v[200:203], v[40:55]
    ds_write_b128 v98, v[92:95] offset:7760
    v_mfma_f32_32x32x16_bf16 v[40:55], v[32:35], v[204:207], v[40:55]
    v_mfma_f32_32x32x16_bf16 v[40:55], v[36:39], v[208:211], v[40:55]
    s_nop 3
    s_nop 7
    s_mov_b64 exec, 1
    v_add_f32 v40, s60, v40
    s_mov_b64 exec, -1
    ds_write_b128 v236, v[40:43]
    ds_write_b64 v237, v[44:45]
    ds_write_b64 v238, v[46:47]
    ds_write_b32 v239, v48 offset:2048
    ds_write_b32 v239, v49 offset:2176
    ds_write_b32 v239, v50 offset:2304
    ds_write_b32 v239, v51 offset:2432
    v_mov_b32 v16, 1
    s_waitcnt lgkmcnt(0)
    ds_write_b32 v249, v16
    s_mov_b32 s63, 100000
B_s1_spin:
    ds_read_b32 v16, v250
    s_sub_u32 s63, s63, 1
    s_cbranch_scc1 B_s1_ok
    s_waitcnt lgkmcnt(0)
    v_cmp_gt_u32 vcc, 1, v16
    s_cbranch_vccnz B_s1_spin
B_s1_ok:
    ds_read2st64_b32 v[184:185], v100 offset0:0 offset1:16
    ds_read2st64_b32 v[186:187], v101 offset0:0 offset1:16
    ds_read2st64_b32 v[188:189], v102 offset0:0 offset1:16
    ds_read2st64_b32 v[190:191], v103 offset0:0 offset1:16
    ds_read2st64_b32 v[192:193], v104 offset0:0 offset1:16
    ds_read2st64_b32 v[194:195], v105 offset0:0 offset1:16
    ds_read2st64_b32 v[196:197], v106 offset0:0 offset1:16
    ds_read2st64_b32 v[198:199], v107 offset0:0 offset1:16
    ds_read2st64_b32 v[200:201], v108 offset0:0 offset1:16
    ds_read2st64_b32 v[202:203], v109 offset0:0 offset1:16
    ds_read2st64_b32 v[204:205], v110 offset0:0 offset1:16
    ds_read2st64_b32 v[206:207], v111 offset0:0 offset1:16
    ds_read2st64_b32 v[208:209], v112 offset0:0 offset1:16
    ds_read2st64_b32 v[210:211], v113 offset0:0 offset1:16
    ds_read2st64_b32 v[212:213], v114 offset0:0 offset1:16
    ds_read2st64_b32 v[214:215], v115 offset0:0 offset1:16
    s_waitcnt lgkmcnt(8)
    v_add_f32 v184, v184, v185
    v_add_f32 v186, v186, v187
    v_add_f32 v188, v188, v189
    v_add_f32 v190, v190, v191
    v_add_f32 v192, v192, v193
    v_add_f32 v194, v194, v195
    v_add_f32 v196, v196, v197
    v_add_f32 v198, v198, v199
    v_cvt_pk_bf16_f32 v216, v184, v186
    v_cvt_pk_bf16_f32 v217, v188, v190
    v_cvt_pk_bf16_f32 v218, v192, v194
    v_cvt_pk_bf16_f32 v219, v196, v198
    ds_write_b128 v241, v[216:219] offset:0
    s_waitcnt lgkmcnt(1)
    v_add_f32 v200, v200, v201
    v_add_f32 v202, v202, v203
    v_add_f32 v204, v204, v205
    v_add_f32 v206, v206, v207
    v_add_f32 v208, v208, v209
    v_add_f32 v210, v210, v211
    v_add_f32 v212, v212, v213
    v_add_f32 v214, v214, v215
    v_cvt_pk_bf16_f32 v220, v200, v202
    v_cvt_pk_bf16_f32 v221, v204, v206
    v_cvt_pk_bf16_f32 v222, v208, v210
    v_cvt_pk_bf16_f32 v223, v212, v214
    ds_write_b128 v241, v[220:223] offset:2048
    v_mov_b32 v16, 2
    s_waitcnt lgkmcnt(0)
    ds_write_b32 v249, v16
    ds_read_b64 v[88:89], v243 offset:192
    ds_read_b64 v[90:91], v243 offset:200
    ds_read_b64 v[92:93], v243 offset:704
    ds_read_b64 v[94:95], v243 offset:712
    ds_read_b64 v[96:97], v243 offset:1216
    ds_read_b64 v[98:99], v243 offset:1224
    ds_read_b64 v[100:101], v243 offset:1728
    ds_read_b64 v[102:103], v243 offset:1736
    ds_read_b64 v[104:105], v243 offset:2240
    ds_read_b64 v[106:107], v243 offset:2248
    ds_read_b64 v[108:109], v243 offset:2752
    ds_read_b64 v[110:111], v243 offset:2760
    ds_read_b64 v[112:113], v243 offset:3264
    ds_read_b64 v[114:115], v243 offset:3272
    ds_read_b64 v[116:117], v243 offset:3776
    ds_read_b64 v[118:119], v243 offset:3784
    s_mov_b32 s63, 100000
B_s2_spin:
    ds_read_b32 v16, v250
    s_sub_u32 s63, s63, 1
    s_cbranch_scc1 B_s2_ok
    s_waitcnt lgkmcnt(0)
    v_cmp_gt_u32 vcc, 2, v16
    s_cbranch_vccnz B_s2_spin
B_s2_ok:
    ds_read_b128 v[56:59], v242 offset:3776
    ds_read_b128 v[60:63], v242 offset:3264
    ds_read_b128 v[64:67], v242 offset:2752
    ds_read_b128 v[68:71], v242 offset:2240
    ds_read_b128 v[72:75], v242 offset:1728
    ds_read_b128 v[76:79], v242 offset:1216
    ds_read_b128 v[80:83], v242 offset:704
    ds_read_b128 v[84:87], v242 offset:192
    s_waitcnt lgkmcnt(7)
    v_mfma_f32_16x16x32_bf16 v[24:27], v[88:91], v[56:59], 0
    v_mfma_f32_16x16x32_bf16 v[28:31], v[92:95], v[56:59], 0
    v_mfma_f32_16x16x32_bf16 v[32:35], v[96:99], v[56:59], 0
    v_mfma_f32_16x16x32_bf16 v[36:39], v[100:103], v[56:59], 0
    v_mfma_f32_16x16x32_bf16 v[40:43], v[104:107], v[56:59], 0
    v_mfma_f32_16x16x32_bf16 v[44:47], v[108:111], v[56:59], 0
    v_mfma_f32_16x16x32_bf16 v[48:51], v[112:115], v[56:59], 0
    v_mfma_f32_16x16x32_bf16 v[52:55], v[116:119], v[56:59], 0
    s_waitcnt lgkmcnt(0)
    v_mfma_f32_16x16x32_bf16 v[28:31], v[88:91], v[60:63], v[28:31]
    ds_read_b128 v[120:123], v242 offset:3712
    v_mfma_f32_16x16x32_bf16 v[32:35], v[92:95], v[60:63], v[32:35]
    ds_read_b64 v[152:153], v243 offset:128
    v_mfma_f32_16x16x32_bf16 v[36:39], v[96:99], v[60:63], v[36:39]
    ds_read_b64 v[154:155], v243 offset:136
    v_mfma_f32_16x16x32_bf16 v[40:43], v[100:103], v[60:63], v[40:43]
    ds_read_b128 v[124:127], v242 offset:3200
    v_mfma_f32_16x16x32_bf16 v[44:47], v[104:107], v[60:63], v[44:47]
    ds_read_b64 v[156:157], v243 offset:640
    v_mfma_f32_16x16x32_bf16 v[48:51], v[108:111], v[60:63], v[48:51]
    ds_read_b64 v[158:159], v243 offset:648
    v_mfma_f32_16x16x32_bf16 v[52:55], v[112:115], v[60:63], v[52:55]
    ds_read_b128 v[128:131], v242 offset:2688
    v_mfma_f32_16x16x32_bf16 v[32:35], v[88:91], v[64:67], v[32:35]
    ds_read_b64 v[160:161], v243 offset:1152
    v_mfma_f32_16x16x32_bf16 v[36:39], v[92:95], v[64:67], v[36:39]
    ds_read_b64 v[162:163], v243 offset:1160
    v_mfma_f32_16x16x32_bf16 v[40:43], v[96:99], v[64:67], v[40:43]
    ds_read_b128 v[132:135], v242 offset:2176
    v_mfma_f32_16x16x32_bf16 v[44:47], v[100:103], v[64:67], v[44:47]
    ds_read_b64 v[164:165], v243 offset:1664
    v_mfma_f32_16x16x32_bf16 v[48:51], v[104:107], v[64:67], v[48:51]
    ds_read_b64 v[166:167], v243 offset:1672
    v_mfma_f32_16x16x32_bf16 v[52:55], v[108:111], v[64:67], v[52:55]
    ds_read_b128 v[136:139], v242 offset:1664
    v_mfma_f32_16x16x32_bf16 v[36:39], v[88:91], v[68:71], v[36:39]
    ds_read_b64 v[168:169], v243 offset:2176
    v_mfma_f32_16x16x32_bf16 v[40:43], v[92:95], v[68:71], v[40:43]
    ds_read_b64 v[170:171], v243 offset:2184
    v_mfma_f32_16x16x32_bf16 v[44:47], v[96:99], v[68:71], v[44:47]
    ds_read_b128 v[140:143], v242 offset:1152
    v_mfma_f32_16x16x32_bf16 v[48:51], v[100:103], v[68:71], v[48:51]
    ds_read_b64 v[172:173], v243 offset:2688
    v_mfma_f32_16x16x32_bf16 v[52:55], v[104:107], v[68:71], v[52:55]
    ds_read_b64 v[174:175], v243 offset:2696
    v_mfma_f32_16x16x32_bf16 v[40:43], v[88:91], v[72:75], v[40:43]
    ds_read_b128 v[144:147], v242 offset:640
    v_mfma_f32_16x16x32_bf16 v[44:47], v[92:95], v[72:75], v[44:47]
    ds_read_b64 v[176:177], v243 offset:3200
    v_mfma_f32_16x16x32_bf16 v[48:51], v[96:99], v[72:75], v[48:51]
    ds_read_b64 v[178:179], v243 offset:3208
    v_mfma_f32_16x16x32_bf16 v[52:55], v[100:103], v[72:75], v[52:55]
    ds_read_b128 v[148:151], v242 offset:128
    v_mfma_f32_16x16x32_bf16 v[44:47], v[88:91], v[76:79], v[44:47]
    ds_read_b64 v[180:181], v243 offset:3712
    v_mfma_f32_16x16x32_bf16 v[48:51], v[92:95], v[76:79], v[48:51]
    ds_read_b64 v[182:183], v243 offset:3720
    v_mfma_f32_16x16x32_bf16 v[52:55], v[96:99], v[76:79], v[52:55]
    v_mfma_f32_16x16x32_bf16 v[48:51], v[88:91], v[80:83], v[48:51]
    v_mfma_f32_16x16x32_bf16 v[52:55], v[92:95], v[80:83], v[52:55]
    v_mfma_f32_16x16x32_bf16 v[52:55], v[88:91], v[84:87], v[52:55]
    s_setprio 1
    s_waitcnt lgkmcnt(0)
    v_mfma_f32_16x16x32_bf16 v[24:27], v[152:155], v[120:123], v[24:27]
    ds_read_b128 v[56:59], v242 offset:3648
    v_mfma_f32_16x16x32_bf16 v[28:31], v[156:159], v[120:123], v[28:31]
    ds_read_b64 v[88:89], v243 offset:64
    v_mfma_f32_16x16x32_bf16 v[32:35], v[160:163], v[120:123], v[32:35]
    ds_read_b64 v[90:91], v243 offset:72
    v_mfma_f32_16x16x32_bf16 v[36:39], v[164:167], v[120:123], v[36:39]
    ds_read_b128 v[60:63], v242 offset:3136
    v_mfma_f32_16x16x32_bf16 v[40:43], v[168:171], v[120:123], v[40:43]
    ds_read_b64 v[92:93], v243 offset:576
    v_mfma_f32_16x16x32_bf16 v[44:47], v[172:175], v[120:123], v[44:47]
    ds_read_b64 v[94:95], v243 offset:584
    v_mfma_f32_16x16x32_bf16 v[48:51], v[176:179], v[120:123], v[48:51]
    ds_read_b128 v[64:67], v242 offset:2624
    v_mfma_f32_16x16x32_bf16 v[52:55], v[180:183], v[120:123], v[52:55]
    ds_read_b64 v[96:97], v243 offset:1088
    v_mfma_f32_16x16x32_bf16 v[28:31], v[152:155], v[124:127], v[28:31]
    ds_read_b64 v[98:99], v243 offset:1096
    v_mfma_f32_16x16x32_bf16 v[32:35], v[156:159], v[124:127], v[32:35]
    ds_read_b128 v[68:71], v242 offset:2112
    v_mfma_f32_16x16x32_bf16 v[36:39], v[160:163], v[124:127], v[36:39]
    ds_read_b64 v[100:101], v243 offset:1600
    v_mfma_f32_16x16x32_bf16 v[40:43], v[164:167], v[124:127], v[40:43]
    ds_read_b64 v[102:103], v243 offset:1608
    v_mfma_f32_16x16x32_bf16 v[44:47], v[168:171], v[124:127], v[44:47]
    ds_read_b128 v[72:75], v242 offset:1600
    v_mfma_f32_16x16x32_bf16 v[48:51], v[172:175], v[124:127], v[48:51]
    ds_read_b64 v[104:105], v243 offset:2112
    v_mfma_f32_16x16x32_bf16 v[52:55], v[176:179], v[124:127], v[52:55]
    ds_read_b64 v[106:107], v243 offset:2120
    v_mfma_f32_16x16x32_bf16 v[32:35], v[152:155], v[128:131], v[32:35]
    ds_read_b128 v[76:79], v242 offset:1088
    v_mfma_f32_16x16x32_bf16 v[36:39], v[156:159], v[128:131], v[36:39]
    ds_read_b64 v[108:109], v243 offset:2624
    v_mfma_f32_16x16x32_bf16 v[40:43], v[160:163], v[128:131], v[40:43]
    ds_read_b64 v[110:111], v243 offset:2632
    v_mfma_f32_16x16x32_bf16 v[44:47], v[164:167], v[128:131], v[44:47]
    ds_read_b128 v[80:83], v242 offset:576
    v_mfma_f32_16x16x32_bf16 v[48:51], v[168:171], v[128:131], v[48:51]
    ds_read_b64 v[112:113], v243 offset:3136
    v_mfma_f32_16x16x32_bf16 v[52:55], v[172:175], v[128:131], v[52:55]
    ds_read_b64 v[114:115], v243 offset:3144
    v_mfma_f32_16x16x32_bf16 v[36:39], v[152:155], v[132:135], v[36:39]
    ds_read_b128 v[84:87], v242 offset:64
    v_mfma_f32_16x16x32_bf16 v[40:43], v[156:159], v[132:135], v[40:43]
    ds_read_b64 v[116:117], v243 offset:3648
    v_mfma_f32_16x16x32_bf16 v[44:47], v[160:163], v[132:135], v[44:47]
    ds_read_b64 v[118:119], v243 offset:3656
    v_mfma_f32_16x16x32_bf16 v[48:51], v[164:167], v[132:135], v[48:51]
    v_mfma_f32_16x16x32_bf16 v[52:55], v[168:171], v[132:135], v[52:55]
    v_mfma_f32_16x16x32_bf16 v[40:43], v[152:155], v[136:139], v[40:43]
    v_mfma_f32_16x16x32_bf16 v[44:47], v[156:159], v[136:139], v[44:47]
    v_mfma_f32_16x16x32_bf16 v[48:51], v[160:163], v[136:139], v[48:51]
    v_mfma_f32_16x16x32_bf16 v[52:55], v[164:167], v[136:139], v[52:55]
    v_mfma_f32_16x16x32_bf16 v[44:47], v[152:155], v[140:143], v[44:47]
    v_mfma_f32_16x16x32_bf16 v[48:51], v[156:159], v[140:143], v[48:51]
    v_mfma_f32_16x16x32_bf16 v[52:55], v[160:163], v[140:143], v[52:55]
    v_mfma_f32_16x16x32_bf16 v[48:51], v[152:155], v[144:147], v[48:51]
    v_mfma_f32_16x16x32_bf16 v[52:55], v[156:159], v[144:147], v[52:55]
    v_mfma_f32_16x16x32_bf16 v[52:55], v[152:155], v[148:151], v[52:55]
    s_waitcnt lgkmcnt(0)
    v_mfma_f32_16x16x32_bf16 v[24:27], v[88:91], v[56:59], v[24:27]
    ds_read_b128 v[120:123], v242 offset:3584
    v_mfma_f32_16x16x32_bf16 v[28:31], v[92:95], v[56:59], v[28:31]
    ds_read_b64 v[152:153], v243 offset:0
    v_mfma_f32_16x16x32_bf16 v[32:35], v[96:99], v[56:59], v[32:35]
    ds_read_b64 v[154:155], v243 offset:8
    v_mfma_f32_16x16x32_bf16 v[36:39], v[100:103], v[56:59], v[36:39]
    ds_read_b128 v[124:127], v242 offset:3072
    v_mfma_f32_16x16x32_bf16 v[40:43], v[104:107], v[56:59], v[40:43]
    ds_read_b64 v[156:157], v243 offset:512
    v_mfma_f32_16x16x32_bf16 v[44:47], v[108:111], v[56:59], v[44:47]
    ds_read_b64 v[158:159], v243 offset:520
    v_mfma_f32_16x16x32_bf16 v[48:51], v[112:115], v[56:59], v[48:51]
    ds_read_b128 v[128:131], v242 offset:2560
    v_mfma_f32_16x16x32_bf16 v[52:55], v[116:119], v[56:59], v[52:55]
    ds_read_b64 v[160:161], v243 offset:1024
    v_mfma_f32_16x16x32_bf16 v[28:31], v[88:91], v[60:63], v[28:31]
    ds_read_b64 v[162:163], v243 offset:1032
    v_mfma_f32_16x16x32_bf16 v[32:35], v[92:95], v[60:63], v[32:35]
    ds_read_b128 v[132:135], v242 offset:2048
    v_mfma_f32_16x16x32_bf16 v[36:39], v[96:99], v[60:63], v[36:39]
    ds_read_b64 v[164:165], v243 offset:1536
    v_mfma_f32_16x16x32_bf16 v[40:43], v[100:103], v[60:63], v[40:43]
    ds_read_b64 v[166:167], v243 offset:1544
    v_mfma_f32_16x16x32_bf16 v[44:47], v[104:107], v[60:63], v[44:47]
    ds_read_b128 v[136:139], v242 offset:1536
    v_mfma_f32_16x16x32_bf16 v[48:51], v[108:111], v[60:63], v[48:51]
    ds_read_b64 v[168:169], v243 offset:2048
    v_mfma_f32_16x16x32_bf16 v[52:55], v[112:115], v[60:63], v[52:55]
    ds_read_b64 v[170:171], v243 offset:2056
    v_mfma_f32_16x16x32_bf16 v[32:35], v[88:91], v[64:67], v[32:35]
    ds_read_b128 v[140:143], v242 offset:1024
    v_mfma_f32_16x16x32_bf16 v[36:39], v[92:95], v[64:67], v[36:39]
    ds_read_b64 v[172:173], v243 offset:2560
    v_mfma_f32_16x16x32_bf16 v[40:43], v[96:99], v[64:67], v[40:43]
    ds_read_b64 v[174:175], v243 offset:2568
    v_mfma_f32_16x16x32_bf16 v[44:47], v[100:103], v[64:67], v[44:47]
    ds_read_b128 v[144:147], v242 offset:512
    v_mfma_f32_16x16x32_bf16 v[48:51], v[104:107], v[64:67], v[48:51]
    ds_read_b64 v[176:177], v243 offset:3072
    v_mfma_f32_16x16x32_bf16 v[52:55], v[108:111], v[64:67], v[52:55]
    ds_read_b64 v[178:179], v243 offset:3080
    v_mfma_f32_16x16x32_bf16 v[36:39], v[88:91], v[68:71], v[36:39]
    ds_read_b128 v[148:151], v242 offset:0
    v_mfma_f32_16x16x32_bf16 v[40:43], v[92:95], v[68:71], v[40:43]
    ds_read_b64 v[180:181], v243 offset:3584
    v_mfma_f32_16x16x32_bf16 v[44:47], v[96:99], v[68:71], v[44:47]
    ds_read_b64 v[182:183], v243 offset:3592
    v_mfma_f32_16x16x32_bf16 v[48:51], v[100:103], v[68:71], v[48:51]
    v_mfma_f32_16x16x32_bf16 v[52:55], v[104:107], v[68:71], v[52:55]
    v_mfma_f32_16x16x32_bf16 v[40:43], v[88:91], v[72:75], v[40:43]
    v_mfma_f32_16x16x32_bf16 v[44:47], v[92:95], v[72:75], v[44:47]
    v_mfma_f32_16x16x32_bf16 v[48:51], v[96:99], v[72:75], v[48:51]
    v_mfma_f32_16x16x32_bf16 v[52:55], v[100:103], v[72:75], v[52:55]
    v_mfma_f32_16x16x32_bf16 v[44:47], v[88:91], v[76:79], v[44:47]
    v_mfma_f32_16x16x32_bf16 v[48:51], v[92:95], v[76:79], v[48:51]
    v_mfma_f32_16x16x32_bf16 v[52:55], v[96:99], v[76:79], v[52:55]
    v_mfma_f32_16x16x32_bf16 v[48:51], v[88:91], v[80:83], v[48:51]
    v_mfma_f32_16x16x32_bf16 v[52:55], v[92:95], v[80:83], v[52:55]
    v_mfma_f32_16x16x32_bf16 v[52:55], v[88:91], v[84:87], v[52:55]
    s_waitcnt lgkmcnt(0)
    v_mfma_f32_16x16x32_bf16 v[24:27], v[152:155], v[120:123], v[24:27]
    v_mfma_f32_16x16x32_bf16 v[28:31], v[156:159], v[120:123], v[28:31]
    v_mfma_f32_16x16x32_bf16 v[32:35], v[160:163], v[120:123], v[32:35]
    v_mfma_f32_16x16x32_bf16 v[36:39], v[164:167], v[120:123], v[36:39]
    v_mfma_f32_16x16x32_bf16 v[40:43], v[168:171], v[120:123], v[40:43]
    v_mfma_f32_16x16x32_bf16 v[44:47], v[172:175], v[120:123], v[44:47]
    v_mfma_f32_16x16x32_bf16 v[48:51], v[176:179], v[120:123], v[48:51]
    v_mfma_f32_16x16x32_bf16 v[52:55], v[180:183], v[120:123], v[52:55]
    v_mfma_f32_16x16x32_bf16 v[28:31], v[152:155], v[124:127], v[28:31]
    v_mfma_f32_16x16x32_bf16 v[32:35], v[156:159], v[124:127], v[32:35]
    v_mfma_f32_16x16x32_bf16 v[36:39], v[160:163], v[124:127], v[36:39]
    v_mfma_f32_16x16x32_bf16 v[40:43], v[164:167], v[124:127], v[40:43]
    v_mfma_f32_16x16x32_bf16 v[44:47], v[168:171], v[124:127], v[44:47]
    v_mfma_f32_16x16x32_bf16 v[48:51], v[172:175], v[124:127], v[48:51]
    v_mfma_f32_16x16x32_bf16 v[52:55], v[176:179], v[124:127], v[52:55]
    v_mfma_f32_16x16x32_bf16 v[32:35], v[152:155], v[128:131], v[32:35]
    v_mfma_f32_16x16x32_bf16 v[36:39], v[156:159], v[128:131], v[36:39]
    v_mfma_f32_16x16x32_bf16 v[40:43], v[160:163], v[128:131], v[40:43]
    v_mfma_f32_16x16x32_bf16 v[44:47], v[164:167], v[128:131], v[44:47]
    v_mfma_f32_16x16x32_bf16 v[48:51], v[168:171], v[128:131], v[48:51]
    v_mfma_f32_16x16x32_bf16 v[52:55], v[172:175], v[128:131], v[52:55]
    v_mfma_f32_16x16x32_bf16 v[36:39], v[152:155], v[132:135], v[36:39]
    v_mfma_f32_16x16x32_bf16 v[40:43], v[156:159], v[132:135], v[40:43]
    v_mfma_f32_16x16x32_bf16 v[44:47], v[160:163], v[132:135], v[44:47]
    v_mfma_f32_16x16x32_bf16 v[48:51], v[164:167], v[132:135], v[48:51]
    v_mfma_f32_16x16x32_bf16 v[52:55], v[168:171], v[132:135], v[52:55]
    v_mfma_f32_16x16x32_bf16 v[40:43], v[152:155], v[136:139], v[40:43]
    v_mfma_f32_16x16x32_bf16 v[44:47], v[156:159], v[136:139], v[44:47]
    v_mfma_f32_16x16x32_bf16 v[48:51], v[160:163], v[136:139], v[48:51]
    v_mfma_f32_16x16x32_bf16 v[52:55], v[164:167], v[136:139], v[52:55]
    v_mfma_f32_16x16x32_bf16 v[44:47], v[152:155], v[140:143], v[44:47]
    v_mfma_f32_16x16x32_bf16 v[48:51], v[156:159], v[140:143], v[48:51]
    v_mfma_f32_16x16x32_bf16 v[52:55], v[160:163], v[140:143], v[52:55]
    v_mfma_f32_16x16x32_bf16 v[48:51], v[152:155], v[144:147], v[48:51]
    v_mfma_f32_16x16x32_bf16 v[52:55], v[156:159], v[144:147], v[52:55]
    v_mfma_f32_16x16x32_bf16 v[52:55], v[152:155], v[148:151], v[52:55]
    s_setprio 0
    s_cmp_eq_u32 s37, 1
    s_cbranch_scc1 B_h1
    s_nop 4
    ds_write_b128 v245, v[40:43] offset:0
    ds_write_b128 v245, v[44:47] offset:1024
    ds_write_b128 v245, v[48:51] offset:2048
    ds_write_b128 v245, v[52:55] offset:3072
    v_mov_b32 v6, 3
    s_waitcnt lgkmcnt(0)
    ds_write_b32 v249, v6
    s_mov_b32 s63, 100000
B_s30_spin:
    ds_read_b32 v6, v250
    s_sub_u32 s63, s63, 1
    s_cbranch_scc1 B_s30_ok
    s_waitcnt lgkmcnt(0)
    v_cmp_gt_u32 vcc, 3, v6
    s_cbranch_vccnz B_s30_spin
B_s30_ok:
    ds_read_b128 v[56:59], v246 offset:0
    ds_read_b128 v[60:63], v246 offset:1024
    ds_read_b128 v[64:67], v246 offset:2048
    ds_read_b128 v[68:71], v246 offset:3072
    s_waitcnt lgkmcnt(3)
    v_add_f32 v56, v24, v56
    v_add_f32 v57, v25, v57
    v_add_f32 v58, v26, v58
    v_add_f32 v59, v27, v59
    s_waitcnt lgkmcnt(2)
    v_add_f32 v60, v28, v60
    v_add_f32 v61, v29, v61
    v_add_f32 v62, v30, v62
    v_add_f32 v63, v31, v63
    s_waitcnt lgkmcnt(1)
    v_add_f32 v64, v32, v64
    v_add_f32 v65, v33, v65
    v_add_f32 v66, v34, v66
    v_add_f32 v67, v35, v67
    s_waitcnt lgkmcnt(0)
    v_add_f32 v68, v36, v68
    v_add_f32 v69, v37, v69
    v_add_f32 v70, v38, v70
    v_add_f32 v71, v39, v71
    s_branch B_hj
B_h1:
    ds_write_b128 v245, v[24:27] offset:0
    ds_write_b128 v245, v[28:31] offset:1024
    ds_write_b128 v245, v[32:35] offset:2048
    ds_write_b128 v245, v[36:39] offset:3072
    v_mov_b32 v6, 3
    s_waitcnt lgkmcnt(0)
    ds_write_b32 v249, v6
    s_mov_b32 s63, 100000
B_s31_spin:
    ds_read_b32 v6, v250
    s_sub_u32 s63, s63, 1
    s_cbranch_scc1 B_s31_ok
    s_waitcnt lgkmcnt(0)
    v_cmp_gt_u32 vcc, 3, v6
    s_cbranch_vccnz B_s31_spin
B_s31_ok:
    ds_read_b128 v[56:59], v246 offset:0
    ds_read_b128 v[60:63], v246 offset:1024
    ds_read_b128 v[64:67], v246 offset:2048
    ds_read_b128 v[68:71], v246 offset:3072
    s_waitcnt lgkmcnt(3)
    v_add_f32 v56, v40, v56
    v_add_f32 v57, v41, v57
    v_add_f32 v58, v42, v58
    v_add_f32 v59, v43, v59
    s_waitcnt lgkmcnt(2)
    v_add_f32 v60, v44, v60
    v_add_f32 v61, v45, v61
    v_add_f32 v62, v46, v62
    v_add_f32 v63, v47, v63
    s_waitcnt lgkmcnt(1)
    v_add_f32 v64, v48, v64
    v_add_f32 v65, v49, v65
    v_add_f32 v66, v50, v66
    v_add_f32 v67, v51, v67
    s_waitcnt lgkmcnt(0)
    v_add_f32 v68, v52, v68
    v_add_f32 v69, v53, v69
    v_add_f32 v70, v54, v70
    v_add_f32 v71, v55, v71
B_hj:
    v_cvt_pk_bf16_f32 v96, v56, v57
    v_cvt_pk_bf16_f32 v97, v58, v59
    v_cvt_pk_bf16_f32 v98, v60, v61
    v_cvt_pk_bf16_f32 v99, v62, v63
    v_cvt_pk_bf16_f32 v100, v64, v65
    v_cvt_pk_bf16_f32 v101, v66, v67
    v_cvt_pk_bf16_f32 v102, v68, v69
    v_cvt_pk_bf16_f32 v103, v70, v71
    s_nop 1
    v_permlane16_swap_b32 v96, v98
    v_permlane16_swap_b32 v97, v99
    v_permlane16_swap_b32 v100, v102
    v_permlane16_swap_b32 v101, v103
    buffer_store_dwordx4 v[96:99], v247, s[24:27], s46 offen offset:0 sc1
    buffer_store_dwordx4 v[100:103], v247, s[24:27], s46 offen offset:1024 sc1
    v_mov_b32 v8, s62
    v_mov_b32 v9, s62
    v_mov_b32 v10, s62
    v_mov_b32 v11, s62
    s_waitcnt vmcnt(0)
    s_mov_b64 exec, 255
    buffer_store_dwordx4 v[8:11], v3, s[48:51], s61 offen sc1
    s_mov_b64 exec, -1
    s_endpgm
K_notAB:
    s_cmp_ge_u32 s2, 256
    s_cbranch_scc1 K_exit
    s_sub_u32 s3, s2, 224
    s_load_dwordx2 s[4:5], s[0:1], 0
    s_load_dwordx8 s[36:43], s[0:1], 80
    s_load_dwordx4 s[56:59], s[0:1], 120
    s_and_b32 s34, s28, 3
    s_lshl_b32 s34, s34, 3
    s_add_u32 s34, s34, 24
    s_load_dwordx2 s[24:25], s[0:1], s34
    s_lshl_b32 s34, s3, 1
    s_lshr_b32 s35, s28, 2
    s_add_u32 s34, s34, s35
    s_mul_i32 s32, s34, 3584
    v_min_u32 v6, 27, v2
    v_lshlrev_b32 v6, 7, v6
    s_mov_b32 s26, 229376
    s_mov_b32 s27, 0x20000
    v_min_u32 v4, 13, v2
    v_lshlrev_b32 v4, 7, v4
    v_min_u32 v5, 7, v2
    v_mul_u32_u24 v5, 896, v5
    s_lshr_b32 s34, s3, 1
    s_lshl_b32 s34, s34, 2
    s_lshr_b32 s35, s28, 1
    s_add_u32 s34, s34, s35
    s_mul_i32 s34, s34, 3584
    s_and_b32 s35, s3, 1
    s_mul_i32 s33, s35, 1792
    s_add_u32 s29, s34, s33
    s_add_u32 s29, s29, 458752
    s_lshr_b32 s34, s3, 3
    s_lshl_b32 s34, s34, 1
    s_add_u32 s34, s34, s35
    s_lshl_b32 s34, s34, 3
    s_add_u32 s34, s34, s28
    s_and_b32 s35, s3, 6
    s_lshl_b32 s35, s35, 5
    s_add_u32 s34, s34, s35
    s_mul_i32 s31, s34, 7168
    s_mov_b32 s54, 1605632
    s_mov_b32 s55, 0x20000
    s_bitcmp1_b32 s28, 0
    s_waitcnt lgkmcnt(0)
    s_cselect_b32 s52, s38, s36
    s_cselect_b32 s53, s39, s37
    s_mov_b32 s8, s4
    s_mov_b32 s9, s5
    s_mov_b32 s10, 1835008
    s_mov_b32 s11, 0x20000
    buffer_load_dword v150, v4, s[52:55], s29 offen
    s_add_u32 s29, s29, 229376
    buffer_load_dword v160, v5, s[8:11], s31 offen offset:256
    s_cmp_eq_u32 s28, 0
    s_cbranch_scc1 P_sk1
    s_waitcnt vmcnt(0)
P_sk1:
    buffer_load_dword v148, v6, s[24:27], s32 offen
    buffer_load_dword v151, v4, s[52:55], s29 offen
    s_add_u32 s29, s29, 229376
    buffer_load_dword v161, v5, s[8:11], s31 offen offset:384
    buffer_load_dword v152, v4, s[52:55], s29 offen
    s_add_u32 s29, s29, 229376
    buffer_load_dword v162, v5, s[8:11], s31 offen offset:512
    buffer_load_dword v153, v4, s[52:55], s29 offen
    s_add_u32 s29, s29, 229376
    buffer_load_dword v163, v5, s[8:11], s31 offen offset:640
    buffer_load_dword v154, v4, s[52:55], s29 offen
    s_add_u32 s29, s29, 229376
    buffer_load_dword v164, v5, s[8:11], s31 offen offset:768
    s_mov_b32 s12, s40
    s_mov_b32 s13, s41
    s_mov_b32 s14, 1605632
    s_mov_b32 s15, 0x20000
    s_mov_b32 s16, s42
    s_mov_b32 s17, s43
    s_mov_b32 s18, 896
    s_mov_b32 s19, 0x20000
    s_mov_b32 s20, s58
    s_mov_b32 s21, s59
    s_mov_b32 s22, 21127168
    s_mov_b32 s23, 0x20000
    s_add_u32 s48, s58, 12615680
    s_addc_u32 s49, s59, 0
    s_mov_b32 s50, 348160
    s_mov_b32 s51, 0x20000
    v_lshlrev_b32 v3, 4, v2
    v_mov_b32 v22, 0
    s_lshl_b32 s30, s3, 3
    s_add_u32 s30, s30, s28
    s_mul_i32 s34, s30, 6272
    v_min_u32 v14, 48, v2
    v_lshlrev_b32 v14, 7, v14
    buffer_load_dword v149, v14, s[12:15], s34 offen
    s_and_b32 s34, s3, 24
    s_add_u32 s34, s34, s28
    s_mul_i32 s32, s34, 9363
    s_lshr_b32 s32, s32, 16
    s_mul_i32 s35, s32, 7
    s_sub_u32 s33, s34, s35
    s_mul_i32 s32, s32, 401408
    s_lshl_b32 s33, s33, 13
    s_add_u32 s39, s32, s33
    v_lshlrev_b32 v10, 7, v2
    s_cmp_eq_u32 s28, 0
    s_cbranch_scc1 P_skm
    s_waitcnt vmcnt(0)
P_skm:
    s_and_b32 s34, s3, 6
    s_lshl_b32 s34, s34, 2
    s_lshr_b32 s35, s3, 3
    s_lshl_b32 s35, s35, 1
    s_add_u32 s34, s34, s35
    s_and_b32 s35, s3, 1
    s_add_u32 s31, s34, s35
    s_lshl_b32 s30, s31, 3
    s_add_u32 s30, s30, s28
    s_mul_i32 s34, s30, 7168
    s_add_u32 s35, s34, 3584
    buffer_load_dwordx4 v[56:59], v3, s[16:19], 0 offen
    buffer_load_dwordx4 v[24:27], v3, s[8:11], s34 offen offset:0
    buffer_load_dwordx4 v[28:31], v3, s[8:11], s34 offen offset:896
    buffer_load_dwordx4 v[32:35], v3, s[8:11], s34 offen offset:1792
    buffer_load_dwordx4 v[36:39], v3, s[8:11], s34 offen offset:2688
    buffer_load_dwordx4 v[40:43], v3, s[8:11], s35 offen offset:0
    buffer_load_dwordx4 v[44:47], v3, s[8:11], s35 offen offset:896
    buffer_load_dwordx4 v[48:51], v3, s[8:11], s35 offen offset:1792
    buffer_load_dwordx4 v[52:55], v3, s[8:11], s35 offen offset:2688
    global_load_dword v20, v22, s[56:57] sc1
    s_waitcnt vmcnt(1)
    v_dot2_f32_bf16 v128, v24, v56, 0
    v_dot2_f32_bf16 v129, v28, v56, 0
    v_dot2_f32_bf16 v130, v32, v56, 0
    v_dot2_f32_bf16 v131, v36, v56, 0
    v_dot2_f32_bf16 v132, v40, v56, 0
    v_dot2_f32_bf16 v133, v44, v56, 0
    v_dot2_f32_bf16 v134, v48, v56, 0
    v_dot2_f32_bf16 v135, v52, v56, 0
    v_dot2_f32_bf16 v128, v25, v57, v128
    v_dot2_f32_bf16 v129, v29, v57, v129
    v_dot2_f32_bf16 v130, v33, v57, v130
    v_dot2_f32_bf16 v131, v37, v57, v131
    v_dot2_f32_bf16 v132, v41, v57, v132
    v_dot2_f32_bf16 v133, v45, v57, v133
    v_dot2_f32_bf16 v134, v49, v57, v134
    v_dot2_f32_bf16 v135, v53, v57, v135
    v_dot2_f32_bf16 v128, v26, v58, v128
    v_dot2_f32_bf16 v129, v30, v58, v129
    v_dot2_f32_bf16 v130, v34, v58, v130
    v_dot2_f32_bf16 v131, v38, v58, v131
    v_dot2_f32_bf16 v132, v42, v58, v132
    v_dot2_f32_bf16 v133, v46, v58, v133
    v_dot2_f32_bf16 v134, v50, v58, v134
    v_dot2_f32_bf16 v135, v54, v58, v135
    v_dot2_f32_bf16 v128, v27, v59, v128
    v_dot2_f32_bf16 v129, v31, v59, v129
    v_dot2_f32_bf16 v130, v35, v59, v130
    v_dot2_f32_bf16 v131, v39, v59, v131
    v_dot2_f32_bf16 v132, v43, v59, v132
    v_dot2_f32_bf16 v133, v47, v59, v133
    v_dot2_f32_bf16 v134, v51, v59, v134
    v_dot2_f32_bf16 v135, v55, v59, v135
    v_add_f32_dpp v128, v128, v128 row_shr:1 row_mask:0xf bank_mask:0xf bound_ctrl:0
    v_add_f32_dpp v129, v129, v129 row_shr:1 row_mask:0xf bank_mask:0xf bound_ctrl:0
    v_add_f32_dpp v130, v130, v130 row_shr:1 row_mask:0xf bank_mask:0xf bound_ctrl:0
    v_add_f32_dpp v131, v131, v131 row_shr:1 row_mask:0xf bank_mask:0xf bound_ctrl:0
    v_add_f32_dpp v132, v132, v132 row_shr:1 row_mask:0xf bank_mask:0xf bound_ctrl:0
    v_add_f32_dpp v133, v133, v133 row_shr:1 row_mask:0xf bank_mask:0xf bound_ctrl:0
    v_add_f32_dpp v134, v134, v134 row_shr:1 row_mask:0xf bank_mask:0xf bound_ctrl:0
    v_add_f32_dpp v135, v135, v135 row_shr:1 row_mask:0xf bank_mask:0xf bound_ctrl:0
    v_add_f32_dpp v128, v128, v128 row_shr:2 row_mask:0xf bank_mask:0xf bound_ctrl:0
    v_add_f32_dpp v129, v129, v129 row_shr:2 row_mask:0xf bank_mask:0xf bound_ctrl:0
    v_add_f32_dpp v130, v130, v130 row_shr:2 row_mask:0xf bank_mask:0xf bound_ctrl:0
    v_add_f32_dpp v131, v131, v131 row_shr:2 row_mask:0xf bank_mask:0xf bound_ctrl:0
    v_add_f32_dpp v132, v132, v132 row_shr:2 row_mask:0xf bank_mask:0xf bound_ctrl:0
    v_add_f32_dpp v133, v133, v133 row_shr:2 row_mask:0xf bank_mask:0xf bound_ctrl:0
    v_add_f32_dpp v134, v134, v134 row_shr:2 row_mask:0xf bank_mask:0xf bound_ctrl:0
    v_add_f32_dpp v135, v135, v135 row_shr:2 row_mask:0xf bank_mask:0xf bound_ctrl:0
    v_add_f32_dpp v128, v128, v128 row_shr:4 row_mask:0xf bank_mask:0xf bound_ctrl:0
    v_add_f32_dpp v129, v129, v129 row_shr:4 row_mask:0xf bank_mask:0xf bound_ctrl:0
    v_add_f32_dpp v130, v130, v130 row_shr:4 row_mask:0xf bank_mask:0xf bound_ctrl:0
    v_add_f32_dpp v131, v131, v131 row_shr:4 row_mask:0xf bank_mask:0xf bound_ctrl:0
    v_add_f32_dpp v132, v132, v132 row_shr:4 row_mask:0xf bank_mask:0xf bound_ctrl:0
    v_add_f32_dpp v133, v133, v133 row_shr:4 row_mask:0xf bank_mask:0xf bound_ctrl:0
    v_add_f32_dpp v134, v134, v134 row_shr:4 row_mask:0xf bank_mask:0xf bound_ctrl:0
    v_add_f32_dpp v135, v135, v135 row_shr:4 row_mask:0xf bank_mask:0xf bound_ctrl:0
    v_add_f32_dpp v128, v128, v128 row_shr:8 row_mask:0xf bank_mask:0xf bound_ctrl:0
    v_add_f32_dpp v129, v129, v129 row_shr:8 row_mask:0xf bank_mask:0xf bound_ctrl:0
    v_add_f32_dpp v130, v130, v130 row_shr:8 row_mask:0xf bank_mask:0xf bound_ctrl:0
    v_add_f32_dpp v131, v131, v131 row_shr:8 row_mask:0xf bank_mask:0xf bound_ctrl:0
    v_add_f32_dpp v132, v132, v132 row_shr:8 row_mask:0xf bank_mask:0xf bound_ctrl:0
    v_add_f32_dpp v133, v133, v133 row_shr:8 row_mask:0xf bank_mask:0xf bound_ctrl:0
    v_add_f32_dpp v134, v134, v134 row_shr:8 row_mask:0xf bank_mask:0xf bound_ctrl:0
    v_add_f32_dpp v135, v135, v135 row_shr:8 row_mask:0xf bank_mask:0xf bound_ctrl:0
    v_add_f32_dpp v128, v128, v128 row_bcast:15 row_mask:0xa bank_mask:0xf bound_ctrl:0
    v_add_f32_dpp v129, v129, v129 row_bcast:15 row_mask:0xa bank_mask:0xf bound_ctrl:0
    v_add_f32_dpp v130, v130, v130 row_bcast:15 row_mask:0xa bank_mask:0xf bound_ctrl:0
    v_add_f32_dpp v131, v131, v131 row_bcast:15 row_mask:0xa bank_mask:0xf bound_ctrl:0
    v_add_f32_dpp v132, v132, v132 row_bcast:15 row_mask:0xa bank_mask:0xf bound_ctrl:0
    v_add_f32_dpp v133, v133, v133 row_bcast:15 row_mask:0xa bank_mask:0xf bound_ctrl:0
    v_add_f32_dpp v134, v134, v134 row_bcast:15 row_mask:0xa bank_mask:0xf bound_ctrl:0
    v_add_f32_dpp v135, v135, v135 row_bcast:15 row_mask:0xa bank_mask:0xf bound_ctrl:0
    v_add_f32_dpp v128, v128, v128 row_bcast:31 row_mask:0xc bank_mask:0xf bound_ctrl:0
    v_add_f32_dpp v129, v129, v129 row_bcast:31 row_mask:0xc bank_mask:0xf bound_ctrl:0
    v_add_f32_dpp v130, v130, v130 row_bcast:31 row_mask:0xc bank_mask:0xf bound_ctrl:0
    v_add_f32_dpp v131, v131, v131 row_bcast:31 row_mask:0xc bank_mask:0xf bound_ctrl:0
    v_add_f32_dpp v132, v132, v132 row_bcast:31 row_mask:0xc bank_mask:0xf bound_ctrl:0
    v_add_f32_dpp v133, v133, v133 row_bcast:31 row_mask:0xc bank_mask:0xf bound_ctrl:0
    v_add_f32_dpp v134, v134, v134 row_bcast:31 row_mask:0xc bank_mask:0xf bound_ctrl:0
    v_add_f32_dpp v135, v135, v135 row_bcast:31 row_mask:0xc bank_mask:0xf bound_ctrl:0
    v_mov_b32 v12, 0
    v_readlane_b32 s40, v128, 63
    v_readlane_b32 s41, v129, 63
    v_readlane_b32 s42, v130, 63
    v_readlane_b32 s43, v131, 63
    v_readlane_b32 s44, v132, 63
    v_readlane_b32 s45, v133, 63
    v_readlane_b32 s46, v134, 63
    v_readlane_b32 s47, v135, 63
    v_writelane_b32 v12, s40, 0
    v_writelane_b32 v12, s41, 1
    v_writelane_b32 v12, s42, 2
    v_writelane_b32 v12, s43, 3
    v_writelane_b32 v12, s44, 4
    v_writelane_b32 v12, s45, 5
    v_writelane_b32 v12, s46, 6
    v_writelane_b32 v12, s47, 7
    v_cvt_pk_bf16_f32 v12, v12, v12
    v_and_b32 v12, 0xffff0000, v12
    v_mul_f32 v12, 0xbfb8aa3b, v12
    v_exp_f32 v12, v12
    s_lshl_b32 s34, s30, 5
    v_add_f32 v12, 1.0, v12
    v_rcp_f32 v12, v12
    s_add_u32 s34, s34, 20070400
    v_cvt_pk_bf16_f32 v12, v12, v12
    v_and_b32 v12, 0xffff0000, v12
    v_lshlrev_b32 v13, 2, v2
    s_mov_b64 exec, 0xff
    buffer_store_dword v12, v13, s[20:23], s34 offen sc1
    s_mov_b64 exec, -1
    s_waitcnt vmcnt(0)
    v_readfirstlane_b32 s62, v20
    s_cmp_eq_u32 s62, 0
    s_cbranch_scc1 P_tag_slow
P_tag_ok:
    s_barrier
    v_mov_b32 v23, s62
    s_lshl_b32 s34, s31, 7
    s_cmp_lg_u32 s28, 0
    s_cbranch_scc1 P_noflag
    v_mov_b32 v24, s62
    v_mov_b32 v25, s62
    v_mov_b32 v26, s62
    v_mov_b32 v27, s62
    s_mov_b64 exec, 0xff
    buffer_store_dwordx4 v[24:27], v3, s[48:51], s34 offen offset:0 sc1
    s_mov_b64 exec, -1
P_noflag:
    s_endpgm
K_exit:
    s_endpgm
A_ring_slow:
    s_mov_b32 s63, 100000
A_ring_spin:
    ds_read_b128 v[16:19], v5
    s_sub_u32 s63, s63, 1
    s_cbranch_scc1 A_ring_ok
    s_waitcnt lgkmcnt(0)
    v_and_b32 v16, v16, v17
    v_and_b32 v18, v18, v19
    v_and_b32 v16, v16, v18
    v_cmp_ne_u32 vcc, 1, v16
    s_cbranch_vccnz A_ring_spin
    s_branch A_ring_ok
A_tag_slow:
    s_mov_b32 s63, 100000
A_tag_spin:
    global_load_dword v0, v23, s[58:59] sc1
    s_sub_u32 s63, s63, 1
    s_cbranch_scc1 A_tag_ok
    s_waitcnt vmcnt(0)
    v_readfirstlane_b32 s62, v0
    s_cmp_eq_u32 s62, 0
    s_cbranch_scc1 A_tag_spin
    s_branch A_tag_ok
A_ph_slow:
    s_mov_b32 s63, 100000
A_ph_spin:
    s_sleep 1
    buffer_load_dword v7, v6, s[48:51], 0 offen sc1
    s_sub_u32 s63, s63, 1
    s_cbranch_scc1 A_ph_ok
    s_waitcnt vmcnt(0)
    v_cmp_ne_u32 vcc, s62, v7
    s_cbranch_vccnz A_ph_spin
    s_branch A_ph_ok
A_ph2_slow:
    s_mov_b32 s63, 100000
A_ph2_spin:
    s_sleep 1
    buffer_load_dword v7, v6, s[48:51], 0 offen sc1
    s_sub_u32 s63, s63, 1
    s_cbranch_scc1 A_ph2_ok
    s_waitcnt vmcnt(0)
    v_cmp_ne_u32 vcc, s62, v7
    s_cbranch_vccnz A_ph2_spin
    s_branch A_ph2_ok
A_pa_slow:
    s_mov_b32 s63, 100000
A_pa_spin:
    s_sleep 1
    buffer_load_dword v5, v12, s[48:51], 0 offen sc1
    s_sub_u32 s63, s63, 1
    s_cbranch_scc1 A_pa_ok
    s_waitcnt vmcnt(0)
    v_cmp_ne_u32 vcc, s62, v5
    s_cbranch_vccnz A_pa_spin
    s_branch A_pa_ok
B_tag_slow:
    s_mov_b32 s63, 100000
B_tag_spin:
    global_load_dword v122, v22, s[58:59] sc1
    s_sub_u32 s63, s63, 1
    s_cbranch_scc1 B_tag_ok
    s_waitcnt vmcnt(0)
    v_readfirstlane_b32 s62, v122
    s_cmp_eq_u32 s62, 0
    s_cbranch_scc1 B_tag_spin
    s_branch B_tag_ok
B_pu_slow:
    s_mov_b32 s63, 100000
B_pu_spin:
    s_sleep 1
    buffer_load_dword v123, v14, s[48:51], 0 offen sc1
    s_sub_u32 s63, s63, 1
    s_cbranch_scc1 B_pu_ok
    s_waitcnt vmcnt(0)
    v_cmp_ne_u32 vcc, s62, v123
    s_cbranch_vccnz B_pu_spin
    s_branch B_pu_ok
P_tag_slow:
    s_mov_b32 s63, 100000
P_tag_spin:
    global_load_dword v20, v22, s[56:57] sc1
    s_sub_u32 s63, s63, 1
    s_cbranch_scc1 P_tag_ok
    s_waitcnt vmcnt(0)
    v_readfirstlane_b32 s62, v20
    s_cmp_eq_u32 s62, 0
    s_cbranch_scc1 P_tag_spin
    s_branch P_tag_ok
K_end:
.section .rodata,"a"
.p2align 6
.amdhsa_kernel gated_mix__ssm_conv_s4__glu_gated_glu__prompt_kernel
  .amdhsa_next_free_vgpr 256
  .amdhsa_next_free_sgpr 96
  .amdhsa_accum_offset 256
  .amdhsa_group_segment_fixed_size 0
  .amdhsa_kernarg_size 136
  .amdhsa_user_sgpr_count 2
  .amdhsa_user_sgpr_kernarg_segment_ptr 1
  .amdhsa_system_sgpr_workgroup_id_x 1
.end_amdhsa_kernel
```
